```python
import torch

def _softmax(x, axis=-1):
    return torch.softmax(x, dim=axis)

def _gelu(x):
    return torch.nn.functional.gelu(x, approximate='tanh')

def _silu(x):
    return torch.nn.functional.silu(x)

def _sigmoid(x):
    return torch.sigmoid(x)

def _layernorm(x, axis=-1, eps=1e-05):
    m = x.mean(dim=axis, keepdim=True)
    v = x.var(dim=axis, keepdim=True, unbiased=False)
    return (x - m) / torch.sqrt(v + eps)

def _scatter_add(tgt, idx, src, axis=0):
    return tgt.clone().index_add_(axis, idx, src)

def _segment_sum(src, seg, n):
    out = torch.zeros((n,) + src.shape[1:], dtype=src.dtype)
    return out.index_add_(0, seg, src)

def _pad(x, pw):
    flat = tuple((v for pair in reversed(pw) for v in pair))
    return torch.nn.functional.pad(x, flat)
kernel_name = 'adaLN_cond__softmax_full_mha__dense_activation_silu__prompt'

def setup_inputs():

    _w = lambda a: (lambda t: t.to(torch.bfloat16) if t.is_floating_point() else t)(torch.as_tensor(a))

    def _A_setup():
        B, S, D = (1, 2048, 448)
        return {'x': _w((lambda *s: torch.randn(*s, dtype=torch.bfloat16) * 0.05)(B, S, D)), 'wqkv': _w((lambda *s: torch.randn(*s, dtype=torch.bfloat16) * 0.05)(D, 3 * D)), 'wo': _w((lambda *s: torch.randn(*s, dtype=torch.bfloat16) * 0.05)(D, D))}
    _A_in = _A_setup()

    def _B_setup():
        B, S, D, F = (1, 2048, 448, 1792)
        return {'x': _w((lambda *s: torch.randn(*s, dtype=torch.bfloat16) * 0.05)(B, S, D)), 'w1': _w((lambda *s: torch.randn(*s, dtype=torch.bfloat16) * 3.2)(D, F) * D ** (-0.5)), 'w2': _w((lambda *s: torch.randn(*s, dtype=torch.bfloat16) * 0.2)(F, D) * F ** (-0.5))}
    _B_in = _B_setup()
    return {'A_x': _A_in['x'], 'A_wqkv': _A_in['wqkv'], 'A_wo': _A_in['wo'], 'B_x': _B_in['x'], 'B_w1': _B_in['w1'], 'B_w2': _B_in['w2'], 'c': _w((lambda *s: torch.randn(*s, dtype=torch.bfloat16) * 0.1)(1, 448) * 8.0), 'w_mod': _w((lambda *s: torch.randn(*s, dtype=torch.bfloat16) * 0.1)(448, 6 * 448) * 448 ** (-0.5) * 8.0)}

def reference(A_x, A_wqkv, A_wo, B_x, B_w1, B_w2, c, w_mod):

    def _A_ref(x, wqkv, wo):
        B, S, D = x.shape
        H = 16
        Dh = D // H
        qkv = (lambda x, *d: x.permute(*d))((x @ wqkv).reshape(B, S, 3, H, Dh), 2, 0, 3, 1, 4)
        q, k, v = (qkv[0], qkv[1], qkv[2])
        scale = Dh ** (-0.5)
        scores = torch.einsum('bhqd,bhkd->bhqk', q, k) * scale
        p = _softmax(scores, axis=-1)
        o = torch.einsum('bhqk,bhkd->bhqd', p, v)
        return (lambda x, *d: x.permute(*d))(o, 0, 2, 1, 3).reshape(B, S, D) @ wo

    def _B_ref(x, w1, w2):
        h = torch.einsum('bsd,df->bsf', x, w1)
        h = _silu(h)
        out = torch.einsum('bsf,fd->bsd', h, w2)
        return out
    x = A_x
    mod = (_silu(c) @ w_mod).reshape(c.shape[0], 6, 1, -1)
    sa, ca, ga, sb, cb, gb = (mod[:, 0].clone(), mod[:, 1].clone(), mod[:, 2].clone(), mod[:, 3].clone(), mod[:, 4].clone(), mod[:, 5].clone())
    h = _layernorm(x, axis=-1) * (1 + ca) + sa
    x = x + ga * _A_ref(h, A_wqkv, A_wo)
    h = _layernorm(x, axis=-1) * (1 + cb) + sb
    x = x + gb * _B_ref(h, B_w1, B_w2)
    return x
```

```asm
; @launch kernel=prep_kernel grid=(268,1,1) block=(256,1,1) lds=33792
; @launch kernel=qkv_kernel grid=(256,1,1) block=(256,1,1) lds=77824
; @launch kernel=attn_kernel grid=(256,1,1) block=(512,1,1) lds=152576
; @launch kernel=ffn1_kernel grid=(224,1,1) block=(256,1,1) lds=116736
; @launch kernel=ffn2_kernel grid=(224,1,1) block=(256,1,1) lds=66560
.amdgcn_target "amdgcn-amd-amdhsa--gfx950"
.text
.globl prep_kernel
.p2align 8
.type prep_kernel,@function
prep_kernel:
    s_cmp_ge_u32 s2, 268
    s_cbranch_scc1 K1_END
    s_load_dwordx16 s[16:31], s[0:1], 0
    s_load_dwordx2 s[32:33], s[0:1], 64
    s_load_dwordx2 s[34:35], s[0:1], 80
    s_waitcnt lgkmcnt(0)
    s_mov_b32 s36, s34
    s_mov_b32 s37, s35
    s_mov_b32 s38, 0x1b00000
    s_mov_b32 s39, 0x00020000
    s_cmp_lt_u32 s2, 48
    s_cbranch_scc1 K1_P
    s_cmp_lt_u32 s2, 132
    s_cbranch_scc1 K1_A
    s_cmp_lt_u32 s2, 196
    s_cbranch_scc1 K1_S
    s_cmp_lt_u32 s2, 212
    s_cbranch_scc1 K1_WO
    s_sub_u32 s3, s2, 212
    v_lshrrev_b32 v8, 6, v0
    s_nop 0
    v_readfirstlane_b32 s6, v8
    v_and_b32 v1, 63, v0
    v_bfe_u32 v3, v0, 5, 1
    v_lshlrev_b32 v6, 4, v1
    s_mov_b32 s48, s26
    s_mov_b32 s49, s27
    s_mov_b32 s50, 0x188000
    s_mov_b32 s51, 0x00020000
    s_mul_i32 s8, s3, 32
    s_mul_i32 s9, s6, 8
    s_add_u32 s8, s8, s9
    s_mul_i32 s8, s8, 896
    s_lshl_b32 s9, s9, 10
    s_mov_b32 m0, s9
    s_nop 0
    buffer_load_dwordx4 v6, s[48:51], s8 offen lds
    s_add_u32 s8, s8, 896
    s_add_u32 s9, s9, 1024
    s_mov_b32 m0, s9
    s_nop 0
    buffer_load_dwordx4 v6, s[48:51], s8 offen lds
    s_add_u32 s8, s8, 896
    s_add_u32 s9, s9, 1024
    s_mov_b32 m0, s9
    s_nop 0
    buffer_load_dwordx4 v6, s[48:51], s8 offen lds
    s_add_u32 s8, s8, 896
    s_add_u32 s9, s9, 1024
    s_mov_b32 m0, s9
    s_nop 0
    buffer_load_dwordx4 v6, s[48:51], s8 offen lds
    s_add_u32 s8, s8, 896
    s_add_u32 s9, s9, 1024
    s_mov_b32 m0, s9
    s_nop 0
    buffer_load_dwordx4 v6, s[48:51], s8 offen lds
    s_add_u32 s8, s8, 896
    s_add_u32 s9, s9, 1024
    s_mov_b32 m0, s9
    s_nop 0
    buffer_load_dwordx4 v6, s[48:51], s8 offen lds
    s_add_u32 s8, s8, 896
    s_add_u32 s9, s9, 1024
    s_mov_b32 m0, s9
    s_nop 0
    buffer_load_dwordx4 v6, s[48:51], s8 offen lds
    s_add_u32 s8, s8, 896
    s_add_u32 s9, s9, 1024
    s_mov_b32 m0, s9
    s_nop 0
    buffer_load_dwordx4 v6, s[48:51], s8 offen lds
    v_bfe_u32 v8, v0, 2, 2
    v_bfe_u32 v9, v0, 5, 1
    v_mad_u32_u24 v8, v9, 4, v8
    v_mul_u32_u24 v5, 1024, v8
    v_and_b32 v8, 3, v0
    v_lshl_add_u32 v5, v8, 3, v5
    v_bfe_u32 v8, v0, 4, 1
    v_lshl_add_u32 v5, v8, 5, v5
    v_cmp_eq_u32 s[58:59], 0, v3
    s_waitcnt vmcnt(0)
    s_barrier
    s_cmp_lg_u32 s6, 0
    s_cbranch_scc1 K1_PL_w2_0
    ds_read_b64_tr_b16 v[16:17], v5 offset:0
    ds_read_b64_tr_b16 v[18:19], v5 offset:8192
    ds_read_b64_tr_b16 v[20:21], v5 offset:16384
    ds_read_b64_tr_b16 v[22:23], v5 offset:24576
    ds_read_b64_tr_b16 v[24:25], v5 offset:64
    ds_read_b64_tr_b16 v[26:27], v5 offset:8256
    ds_read_b64_tr_b16 v[28:29], v5 offset:16448
    ds_read_b64_tr_b16 v[30:31], v5 offset:24640
    ds_read_b64_tr_b16 v[32:33], v5 offset:128
    ds_read_b64_tr_b16 v[34:35], v5 offset:8320
    ds_read_b64_tr_b16 v[36:37], v5 offset:16512
    ds_read_b64_tr_b16 v[38:39], v5 offset:24704
    ds_read_b64_tr_b16 v[40:41], v5 offset:192
    ds_read_b64_tr_b16 v[42:43], v5 offset:8384
    s_waitcnt lgkmcnt(0)
    s_lshl_b32 s10, s3, 11
    s_add_u32 s10, s10, 0x500000
    buffer_store_dwordx4 v[16:19], v6, s[36:39], s10 offen sc1
    s_lshl_b32 s10, s3, 11
    s_add_u32 s10, s10, 0x500400
    buffer_store_dwordx4 v[20:23], v6, s[36:39], s10 offen sc1
    s_lshl_b32 s10, s3, 11
    s_add_u32 s10, s10, 0x51c000
    buffer_store_dwordx4 v[24:27], v6, s[36:39], s10 offen sc1
    s_lshl_b32 s10, s3, 11
    s_add_u32 s10, s10, 0x51c400
    buffer_store_dwordx4 v[28:31], v6, s[36:39], s10 offen sc1
    s_lshl_b32 s10, s3, 11
    s_add_u32 s10, s10, 0x538000
    buffer_store_dwordx4 v[32:35], v6, s[36:39], s10 offen sc1
    s_lshl_b32 s10, s3, 11
    s_add_u32 s10, s10, 0x538400
    buffer_store_dwordx4 v[36:39], v6, s[36:39], s10 offen sc1
    s_lshl_b32 s10, s3, 11
    s_add_u32 s10, s10, 0x554000
    buffer_store_dwordx4 v[40:43], v6, s[36:39], s10 offen sc1
    s_endpgm
K1_PL_w2_0:
    s_cmp_lg_u32 s6, 1
    s_cbranch_scc1 K1_PL_w2_1
    ds_read_b64_tr_b16 v[16:17], v5 offset:16576
    ds_read_b64_tr_b16 v[18:19], v5 offset:24768
    ds_read_b64_tr_b16 v[20:21], v5 offset:256
    ds_read_b64_tr_b16 v[22:23], v5 offset:8448
    ds_read_b64_tr_b16 v[24:25], v5 offset:16640
    ds_read_b64_tr_b16 v[26:27], v5 offset:24832
    ds_read_b64_tr_b16 v[28:29], v5 offset:320
    ds_read_b64_tr_b16 v[30:31], v5 offset:8512
    ds_read_b64_tr_b16 v[32:33], v5 offset:16704
    ds_read_b64_tr_b16 v[34:35], v5 offset:24896
    ds_read_b64_tr_b16 v[36:37], v5 offset:384
    ds_read_b64_tr_b16 v[38:39], v5 offset:8576
    ds_read_b64_tr_b16 v[40:41], v5 offset:16768
    ds_read_b64_tr_b16 v[42:43], v5 offset:24960
    s_waitcnt lgkmcnt(0)
    s_lshl_b32 s10, s3, 11
    s_add_u32 s10, s10, 0x554400
    buffer_store_dwordx4 v[16:19], v6, s[36:39], s10 offen sc1
    s_lshl_b32 s10, s3, 11
    s_add_u32 s10, s10, 0x570000
    buffer_store_dwordx4 v[20:23], v6, s[36:39], s10 offen sc1
    s_lshl_b32 s10, s3, 11
    s_add_u32 s10, s10, 0x570400
    buffer_store_dwordx4 v[24:27], v6, s[36:39], s10 offen sc1
    s_lshl_b32 s10, s3, 11
    s_add_u32 s10, s10, 0x58c000
    buffer_store_dwordx4 v[28:31], v6, s[36:39], s10 offen sc1
    s_lshl_b32 s10, s3, 11
    s_add_u32 s10, s10, 0x58c400
    buffer_store_dwordx4 v[32:35], v6, s[36:39], s10 offen sc1
    s_lshl_b32 s10, s3, 11
    s_add_u32 s10, s10, 0x5a8000
    buffer_store_dwordx4 v[36:39], v6, s[36:39], s10 offen sc1
    s_lshl_b32 s10, s3, 11
    s_add_u32 s10, s10, 0x5a8400
    buffer_store_dwordx4 v[40:43], v6, s[36:39], s10 offen sc1
    s_endpgm
K1_PL_w2_1:
    s_cmp_lg_u32 s6, 2
    s_cbranch_scc1 K1_PL_w2_2
    ds_read_b64_tr_b16 v[16:17], v5 offset:448
    ds_read_b64_tr_b16 v[18:19], v5 offset:8640
    ds_read_b64_tr_b16 v[20:21], v5 offset:16832
    ds_read_b64_tr_b16 v[22:23], v5 offset:25024
    ds_read_b64_tr_b16 v[24:25], v5 offset:512
    ds_read_b64_tr_b16 v[26:27], v5 offset:8704
    ds_read_b64_tr_b16 v[28:29], v5 offset:16896
    ds_read_b64_tr_b16 v[30:31], v5 offset:25088
    ds_read_b64_tr_b16 v[32:33], v5 offset:576
    ds_read_b64_tr_b16 v[34:35], v5 offset:8768
    ds_read_b64_tr_b16 v[36:37], v5 offset:16960
    ds_read_b64_tr_b16 v[38:39], v5 offset:25152
    ds_read_b64_tr_b16 v[40:41], v5 offset:640
    ds_read_b64_tr_b16 v[42:43], v5 offset:8832
    s_waitcnt lgkmcnt(0)
    s_lshl_b32 s10, s3, 11
    s_add_u32 s10, s10, 0x5c4000
    buffer_store_dwordx4 v[16:19], v6, s[36:39], s10 offen sc1
    s_lshl_b32 s10, s3, 11
    s_add_u32 s10, s10, 0x5c4400
    buffer_store_dwordx4 v[20:23], v6, s[36:39], s10 offen sc1
    s_lshl_b32 s10, s3, 11
    s_add_u32 s10, s10, 0x5e0000
    buffer_store_dwordx4 v[24:27], v6, s[36:39], s10 offen sc1
    s_lshl_b32 s10, s3, 11
    s_add_u32 s10, s10, 0x5e0400
    buffer_store_dwordx4 v[28:31], v6, s[36:39], s10 offen sc1
    s_lshl_b32 s10, s3, 11
    s_add_u32 s10, s10, 0x5fc000
    buffer_store_dwordx4 v[32:35], v6, s[36:39], s10 offen sc1
    s_lshl_b32 s10, s3, 11
    s_add_u32 s10, s10, 0x5fc400
    buffer_store_dwordx4 v[36:39], v6, s[36:39], s10 offen sc1
    s_lshl_b32 s10, s3, 11
    s_add_u32 s10, s10, 0x618000
    buffer_store_dwordx4 v[40:43], v6, s[36:39], s10 offen sc1
    s_endpgm
K1_PL_w2_2:
    s_cmp_lg_u32 s6, 3
    s_cbranch_scc1 K1_PL_w2_3
    ds_read_b64_tr_b16 v[16:17], v5 offset:17024
    ds_read_b64_tr_b16 v[18:19], v5 offset:25216
    ds_read_b64_tr_b16 v[20:21], v5 offset:704
    ds_read_b64_tr_b16 v[22:23], v5 offset:8896
    ds_read_b64_tr_b16 v[24:25], v5 offset:17088
    ds_read_b64_tr_b16 v[26:27], v5 offset:25280
    ds_read_b64_tr_b16 v[28:29], v5 offset:768
    ds_read_b64_tr_b16 v[30:31], v5 offset:8960
    ds_read_b64_tr_b16 v[32:33], v5 offset:17152
    ds_read_b64_tr_b16 v[34:35], v5 offset:25344
    ds_read_b64_tr_b16 v[36:37], v5 offset:832
    ds_read_b64_tr_b16 v[38:39], v5 offset:9024
    ds_read_b64_tr_b16 v[40:41], v5 offset:17216
    ds_read_b64_tr_b16 v[42:43], v5 offset:25408
    s_waitcnt lgkmcnt(0)
    s_lshl_b32 s10, s3, 11
    s_add_u32 s10, s10, 0x618400
    buffer_store_dwordx4 v[16:19], v6, s[36:39], s10 offen sc1
    s_lshl_b32 s10, s3, 11
    s_add_u32 s10, s10, 0x634000
    buffer_store_dwordx4 v[20:23], v6, s[36:39], s10 offen sc1
    s_lshl_b32 s10, s3, 11
    s_add_u32 s10, s10, 0x634400
    buffer_store_dwordx4 v[24:27], v6, s[36:39], s10 offen sc1
    s_lshl_b32 s10, s3, 11
    s_add_u32 s10, s10, 0x650000
    buffer_store_dwordx4 v[28:31], v6, s[36:39], s10 offen sc1
    s_lshl_b32 s10, s3, 11
    s_add_u32 s10, s10, 0x650400
    buffer_store_dwordx4 v[32:35], v6, s[36:39], s10 offen sc1
    s_lshl_b32 s10, s3, 11
    s_add_u32 s10, s10, 0x66c000
    buffer_store_dwordx4 v[36:39], v6, s[36:39], s10 offen sc1
    s_lshl_b32 s10, s3, 11
    s_add_u32 s10, s10, 0x66c400
    buffer_store_dwordx4 v[40:43], v6, s[36:39], s10 offen sc1
    s_endpgm
K1_PL_w2_3:
    s_endpgm
K1_S:
    s_sub_u32 s3, s2, 132
    v_lshrrev_b32 v8, 6, v0
    s_nop 0
    v_readfirstlane_b32 s6, v8
    v_and_b32 v1, 63, v0
    v_and_b32 v2, 31, v0
    v_bfe_u32 v3, v0, 5, 1
    v_lshlrev_b32 v4, 4, v1
    s_mov_b32 s48, s16
    s_mov_b32 s49, s17
    s_mov_b32 s50, 0x1c0000
    s_mov_b32 s51, 0x00020000
    s_mul_i32 s8, s3, 28672
    s_mul_i32 s9, s6, 7168
    s_add_u32 s8, s8, s9
    s_add_u32 s9, s9, 1024
    s_mov_b32 m0, s9
    s_nop 0
    buffer_load_dwordx4 v4, s[48:51], s8 offen lds
    s_add_u32 s8, s8, 1024
    s_add_u32 s9, s9, 1024
    s_mov_b32 m0, s9
    s_nop 0
    buffer_load_dwordx4 v4, s[48:51], s8 offen lds
    s_add_u32 s8, s8, 1024
    s_add_u32 s9, s9, 1024
    s_mov_b32 m0, s9
    s_nop 0
    buffer_load_dwordx4 v4, s[48:51], s8 offen lds
    s_add_u32 s8, s8, 1024
    s_add_u32 s9, s9, 1024
    s_mov_b32 m0, s9
    s_nop 0
    buffer_load_dwordx4 v4, s[48:51], s8 offen lds
    s_add_u32 s8, s8, 1024
    s_add_u32 s9, s9, 1024
    s_mov_b32 m0, s9
    s_nop 0
    buffer_load_dwordx4 v4, s[48:51], s8 offen lds
    s_add_u32 s8, s8, 1024
    s_add_u32 s9, s9, 1024
    s_mov_b32 m0, s9
    s_nop 0
    buffer_load_dwordx4 v4, s[48:51], s8 offen lds
    s_add_u32 s8, s8, 1024
    s_add_u32 s9, s9, 1024
    s_mov_b32 m0, s9
    s_nop 0
    buffer_load_dwordx4 v4, s[48:51], s8 offen lds
    v_mul_u32_u24 v5, 896, v2
    v_lshl_add_u32 v5, v3, 4, v5
    s_mul_i32 s9, s6, 224
    v_add_u32 v5, s9, v5
    v_mov_b32 v10, 0
    v_mov_b32 v11, 0
    v_mov_b32 v12, 0x3f803f80
    s_waitcnt vmcnt(0)
    s_barrier
    ds_read_b128 v[16:19], v5 offset:1024
    ds_read_b128 v[20:23], v5 offset:1056
    ds_read_b128 v[24:27], v5 offset:1088
    ds_read_b128 v[28:31], v5 offset:1120
    ds_read_b128 v[32:35], v5 offset:1152
    ds_read_b128 v[36:39], v5 offset:1184
    ds_read_b128 v[40:43], v5 offset:1216
    s_mul_i32 s8, s3, 28
    s_mul_i32 s9, s6, 7
    s_add_u32 s8, s8, s9
    s_lshl_b32 s8, s8, 10
    s_add_u32 s8, s8, 0x1800000
    s_add_u32 s9, s8, 4096
    s_waitcnt lgkmcnt(0)
    v_dot2_f32_bf16 v10, v16, v12, v10
    v_dot2_f32_bf16 v11, v16, v16, v11
    v_dot2_f32_bf16 v10, v17, v12, v10
    v_dot2_f32_bf16 v11, v17, v17, v11
    v_dot2_f32_bf16 v10, v18, v12, v10
    v_dot2_f32_bf16 v11, v18, v18, v11
    v_dot2_f32_bf16 v10, v19, v12, v10
    v_dot2_f32_bf16 v11, v19, v19, v11
    v_dot2_f32_bf16 v10, v20, v12, v10
    v_dot2_f32_bf16 v11, v20, v20, v11
    v_dot2_f32_bf16 v10, v21, v12, v10
    v_dot2_f32_bf16 v11, v21, v21, v11
    v_dot2_f32_bf16 v10, v22, v12, v10
    v_dot2_f32_bf16 v11, v22, v22, v11
    v_dot2_f32_bf16 v10, v23, v12, v10
    v_dot2_f32_bf16 v11, v23, v23, v11
    v_dot2_f32_bf16 v10, v24, v12, v10
    v_dot2_f32_bf16 v11, v24, v24, v11
    v_dot2_f32_bf16 v10, v25, v12, v10
    v_dot2_f32_bf16 v11, v25, v25, v11
    v_dot2_f32_bf16 v10, v26, v12, v10
    v_dot2_f32_bf16 v11, v26, v26, v11
    v_dot2_f32_bf16 v10, v27, v12, v10
    v_dot2_f32_bf16 v11, v27, v27, v11
    v_dot2_f32_bf16 v10, v28, v12, v10
    v_dot2_f32_bf16 v11, v28, v28, v11
    v_dot2_f32_bf16 v10, v29, v12, v10
    v_dot2_f32_bf16 v11, v29, v29, v11
    v_dot2_f32_bf16 v10, v30, v12, v10
    v_dot2_f32_bf16 v11, v30, v30, v11
    v_dot2_f32_bf16 v10, v31, v12, v10
    v_dot2_f32_bf16 v11, v31, v31, v11
    v_dot2_f32_bf16 v10, v32, v12, v10
    v_dot2_f32_bf16 v11, v32, v32, v11
    v_dot2_f32_bf16 v10, v33, v12, v10
    v_dot2_f32_bf16 v11, v33, v33, v11
    v_dot2_f32_bf16 v10, v34, v12, v10
    v_dot2_f32_bf16 v11, v34, v34, v11
    v_dot2_f32_bf16 v10, v35, v12, v10
    v_dot2_f32_bf16 v11, v35, v35, v11
    v_dot2_f32_bf16 v10, v36, v12, v10
    v_dot2_f32_bf16 v11, v36, v36, v11
    v_dot2_f32_bf16 v10, v37, v12, v10
    v_dot2_f32_bf16 v11, v37, v37, v11
    v_dot2_f32_bf16 v10, v38, v12, v10
    v_dot2_f32_bf16 v11, v38, v38, v11
    v_dot2_f32_bf16 v10, v39, v12, v10
    v_dot2_f32_bf16 v11, v39, v39, v11
    v_dot2_f32_bf16 v10, v40, v12, v10
    v_dot2_f32_bf16 v11, v40, v40, v11
    v_dot2_f32_bf16 v10, v41, v12, v10
    v_dot2_f32_bf16 v11, v41, v41, v11
    v_dot2_f32_bf16 v10, v42, v12, v10
    v_dot2_f32_bf16 v11, v42, v42, v11
    v_dot2_f32_bf16 v10, v43, v12, v10
    v_dot2_f32_bf16 v11, v43, v43, v11
    s_nop 2
    v_permlane32_swap_b32 v10, v11
    v_add_f32 v10, v10, v11
    v_lshlrev_b32 v6, 2, v0
    ds_write_b32 v6, v10
    s_waitcnt lgkmcnt(0)
    s_barrier
    v_lshlrev_b32 v6, 2, v2
    ds_read_b32 v50, v6 offset:0
    ds_read_b32 v54, v6 offset:128
    ds_read_b32 v51, v6 offset:256
    ds_read_b32 v55, v6 offset:384
    ds_read_b32 v52, v6 offset:512
    ds_read_b32 v56, v6 offset:640
    ds_read_b32 v53, v6 offset:768
    ds_read_b32 v57, v6 offset:896
    s_waitcnt lgkmcnt(0)
    v_add_f32 v50, v50, v51
    v_add_f32 v52, v52, v53
    v_add_f32 v10, v50, v52
    v_add_f32 v54, v54, v55
    v_add_f32 v56, v56, v57
    v_add_f32 v11, v54, v56
    s_mov_b32 s10, 0x3b124925
    v_mul_f32 v10, s10, v10
    v_mul_f32 v11, s10, v11
    v_fma_f32 v11, -v10, v10, v11
    v_max_f32 v11, 0, v11
    v_add_f32 v11, 0x3727c5ac, v11
    v_rsq_f32 v12, v11
    s_nop 0
    v_mul_f32 v13, v12, v10
    v_sub_f32 v13, 0, v13
    v_lshlrev_b32 v60, 16, v16
    v_and_b32 v61, 0xffff0000, v16
    v_fma_f32 v60, v60, v12, v13
    v_fma_f32 v61, v61, v12, v13
    v_cvt_pk_bf16_f32 v16, v60, v61
    v_lshlrev_b32 v60, 16, v17
    v_and_b32 v61, 0xffff0000, v17
    v_fma_f32 v60, v60, v12, v13
    v_fma_f32 v61, v61, v12, v13
    v_cvt_pk_bf16_f32 v17, v60, v61
    v_lshlrev_b32 v60, 16, v18
    v_and_b32 v61, 0xffff0000, v18
    v_fma_f32 v60, v60, v12, v13
    v_fma_f32 v61, v61, v12, v13
    v_cvt_pk_bf16_f32 v18, v60, v61
    v_lshlrev_b32 v60, 16, v19
    v_and_b32 v61, 0xffff0000, v19
    v_fma_f32 v60, v60, v12, v13
    v_fma_f32 v61, v61, v12, v13
    v_cvt_pk_bf16_f32 v19, v60, v61
    v_lshlrev_b32 v60, 16, v20
    v_and_b32 v61, 0xffff0000, v20
    v_fma_f32 v60, v60, v12, v13
    v_fma_f32 v61, v61, v12, v13
    v_cvt_pk_bf16_f32 v20, v60, v61
    v_lshlrev_b32 v60, 16, v21
    v_and_b32 v61, 0xffff0000, v21
    v_fma_f32 v60, v60, v12, v13
    v_fma_f32 v61, v61, v12, v13
    v_cvt_pk_bf16_f32 v21, v60, v61
    v_lshlrev_b32 v60, 16, v22
    v_and_b32 v61, 0xffff0000, v22
    v_fma_f32 v60, v60, v12, v13
    v_fma_f32 v61, v61, v12, v13
    v_cvt_pk_bf16_f32 v22, v60, v61
    v_lshlrev_b32 v60, 16, v23
    v_and_b32 v61, 0xffff0000, v23
    v_fma_f32 v60, v60, v12, v13
    v_fma_f32 v61, v61, v12, v13
    v_cvt_pk_bf16_f32 v23, v60, v61
    v_lshlrev_b32 v60, 16, v24
    v_and_b32 v61, 0xffff0000, v24
    v_fma_f32 v60, v60, v12, v13
    v_fma_f32 v61, v61, v12, v13
    v_cvt_pk_bf16_f32 v24, v60, v61
    v_lshlrev_b32 v60, 16, v25
    v_and_b32 v61, 0xffff0000, v25
    v_fma_f32 v60, v60, v12, v13
    v_fma_f32 v61, v61, v12, v13
    v_cvt_pk_bf16_f32 v25, v60, v61
    v_lshlrev_b32 v60, 16, v26
    v_and_b32 v61, 0xffff0000, v26
    v_fma_f32 v60, v60, v12, v13
    v_fma_f32 v61, v61, v12, v13
    v_cvt_pk_bf16_f32 v26, v60, v61
    v_lshlrev_b32 v60, 16, v27
    v_and_b32 v61, 0xffff0000, v27
    v_fma_f32 v60, v60, v12, v13
    v_fma_f32 v61, v61, v12, v13
    v_cvt_pk_bf16_f32 v27, v60, v61
    v_lshlrev_b32 v60, 16, v28
    v_and_b32 v61, 0xffff0000, v28
    v_fma_f32 v60, v60, v12, v13
    v_fma_f32 v61, v61, v12, v13
    v_cvt_pk_bf16_f32 v28, v60, v61
    v_lshlrev_b32 v60, 16, v29
    v_and_b32 v61, 0xffff0000, v29
    v_fma_f32 v60, v60, v12, v13
    v_fma_f32 v61, v61, v12, v13
    v_cvt_pk_bf16_f32 v29, v60, v61
    v_lshlrev_b32 v60, 16, v30
    v_and_b32 v61, 0xffff0000, v30
    v_fma_f32 v60, v60, v12, v13
    v_fma_f32 v61, v61, v12, v13
    v_cvt_pk_bf16_f32 v30, v60, v61
    v_lshlrev_b32 v60, 16, v31
    v_and_b32 v61, 0xffff0000, v31
    v_fma_f32 v60, v60, v12, v13
    v_fma_f32 v61, v61, v12, v13
    v_cvt_pk_bf16_f32 v31, v60, v61
    v_lshlrev_b32 v60, 16, v32
    v_and_b32 v61, 0xffff0000, v32
    v_fma_f32 v60, v60, v12, v13
    v_fma_f32 v61, v61, v12, v13
    v_cvt_pk_bf16_f32 v32, v60, v61
    v_lshlrev_b32 v60, 16, v33
    v_and_b32 v61, 0xffff0000, v33
    v_fma_f32 v60, v60, v12, v13
    v_fma_f32 v61, v61, v12, v13
    v_cvt_pk_bf16_f32 v33, v60, v61
    v_lshlrev_b32 v60, 16, v34
    v_and_b32 v61, 0xffff0000, v34
    v_fma_f32 v60, v60, v12, v13
    v_fma_f32 v61, v61, v12, v13
    v_cvt_pk_bf16_f32 v34, v60, v61
    v_lshlrev_b32 v60, 16, v35
    v_and_b32 v61, 0xffff0000, v35
    v_fma_f32 v60, v60, v12, v13
    v_fma_f32 v61, v61, v12, v13
    v_cvt_pk_bf16_f32 v35, v60, v61
    v_lshlrev_b32 v60, 16, v36
    v_and_b32 v61, 0xffff0000, v36
    v_fma_f32 v60, v60, v12, v13
    v_fma_f32 v61, v61, v12, v13
    v_cvt_pk_bf16_f32 v36, v60, v61
    v_lshlrev_b32 v60, 16, v37
    v_and_b32 v61, 0xffff0000, v37
    v_fma_f32 v60, v60, v12, v13
    v_fma_f32 v61, v61, v12, v13
    v_cvt_pk_bf16_f32 v37, v60, v61
    v_lshlrev_b32 v60, 16, v38
    v_and_b32 v61, 0xffff0000, v38
    v_fma_f32 v60, v60, v12, v13
    v_fma_f32 v61, v61, v12, v13
    v_cvt_pk_bf16_f32 v38, v60, v61
    v_lshlrev_b32 v60, 16, v39
    v_and_b32 v61, 0xffff0000, v39
    v_fma_f32 v60, v60, v12, v13
    v_fma_f32 v61, v61, v12, v13
    v_cvt_pk_bf16_f32 v39, v60, v61
    v_lshlrev_b32 v60, 16, v40
    v_and_b32 v61, 0xffff0000, v40
    v_fma_f32 v60, v60, v12, v13
    v_fma_f32 v61, v61, v12, v13
    v_cvt_pk_bf16_f32 v40, v60, v61
    v_lshlrev_b32 v60, 16, v41
    v_and_b32 v61, 0xffff0000, v41
    v_fma_f32 v60, v60, v12, v13
    v_fma_f32 v61, v61, v12, v13
    v_cvt_pk_bf16_f32 v41, v60, v61
    v_lshlrev_b32 v60, 16, v42
    v_and_b32 v61, 0xffff0000, v42
    v_fma_f32 v60, v60, v12, v13
    v_fma_f32 v61, v61, v12, v13
    v_cvt_pk_bf16_f32 v42, v60, v61
    v_lshlrev_b32 v60, 16, v43
    v_and_b32 v61, 0xffff0000, v43
    v_fma_f32 v60, v60, v12, v13
    v_fma_f32 v61, v61, v12, v13
    v_cvt_pk_bf16_f32 v43, v60, v61
    buffer_store_dwordx4 v[16:19], v4, s[36:39], s8 offen offset:0 sc1
    buffer_store_dwordx4 v[20:23], v4, s[36:39], s8 offen offset:1024 sc1
    buffer_store_dwordx4 v[24:27], v4, s[36:39], s8 offen offset:2048 sc1
    buffer_store_dwordx4 v[28:31], v4, s[36:39], s8 offen offset:3072 sc1
    buffer_store_dwordx4 v[32:35], v4, s[36:39], s9 offen offset:0 sc1
    buffer_store_dwordx4 v[36:39], v4, s[36:39], s9 offen offset:1024 sc1
    buffer_store_dwordx4 v[40:43], v4, s[36:39], s9 offen offset:2048 sc1
    s_endpgm
K1_A:
    s_sub_u32 s3, s2, 48
    s_mul_i32 s4, s3, 4682
    s_lshr_b32 s4, s4, 16
    s_mul_i32 s5, s4, 14
    s_sub_u32 s5, s3, s5
    v_lshrrev_b32 v8, 6, v0
    s_nop 0
    v_readfirstlane_b32 s6, v8
    v_and_b32 v244, 63, v0
    v_and_b32 v245, 31, v0
    v_bfe_u32 v246, v0, 5, 1
    s_mov_b32 s48, s18
    s_mov_b32 s49, s19
    s_mov_b32 s50, 0x126000
    s_mov_b32 s51, 0x00020000
    s_mul_i32 s7, s4, 448
    v_mul_u32_u24 v247, 2688, v246
    v_lshl_add_u32 v247, v245, 4, v247
    s_lshl_b32 s8, s5, 5
    s_lshl_b32 s9, s6, 3
    s_add_u32 s8, s8, s9
    s_mul_i32 s8, s8, 2688
    s_add_u32 s8, s8, s7
    s_lshl_b32 s9, s6, 12
    s_mov_b32 m0, s9
    s_nop 0
    buffer_load_dwordx4 v247, s[48:51], s8 offen lds
    s_add_u32 s8, s8, 5376
    s_add_u32 s9, s9, 1024
    s_mov_b32 m0, s9
    s_nop 0
    buffer_load_dwordx4 v247, s[48:51], s8 offen lds
    s_add_u32 s8, s8, 5376
    s_add_u32 s9, s9, 1024
    s_mov_b32 m0, s9
    s_nop 0
    buffer_load_dwordx4 v247, s[48:51], s8 offen lds
    s_add_u32 s8, s8, 5376
    s_add_u32 s9, s9, 1024
    s_mov_b32 m0, s9
    s_nop 0
    buffer_load_dwordx4 v247, s[48:51], s8 offen lds
    v_bfe_u32 v8, v0, 2, 2
    v_bfe_u32 v9, v0, 5, 1
    v_mad_u32_u24 v8, v9, 4, v8
    v_mul_u32_u24 v248, 512, v8
    v_and_b32 v8, 3, v0
    v_lshl_add_u32 v248, v8, 3, v248
    v_bfe_u32 v8, v0, 4, 1
    v_lshl_add_u32 v248, v8, 5, v248
    s_mul_i32 s9, s6, 112
    v_add_u32 v248, s9, v248
    s_waitcnt vmcnt(0)
    s_barrier
    ds_read_b64_tr_b16 v[100:101], v248 offset:0
    ds_read_b64_tr_b16 v[102:103], v248 offset:4096
    ds_read_b64_tr_b16 v[104:105], v248 offset:8192
    ds_read_b64_tr_b16 v[106:107], v248 offset:12288
    ds_read_b64_tr_b16 v[108:109], v248 offset:56
    ds_read_b64_tr_b16 v[110:111], v248 offset:4152
    ds_read_b64_tr_b16 v[112:113], v248 offset:8248
    ds_read_b64_tr_b16 v[114:115], v248 offset:12344
    v_lshlrev_b32 v250, 4, v244
    v_lshlrev_b32 v251, 2, v244
    v_cmp_gt_u32 s[58:59], 28, v245
    s_waitcnt lgkmcnt(0)
    s_nop 0
    v_cndmask_b32 v100, 0, v100, s[58:59]
    v_cndmask_b32 v101, 0, v101, s[58:59]
    v_cndmask_b32 v102, 0, v102, s[58:59]
    v_cndmask_b32 v103, 0, v103, s[58:59]
    v_cndmask_b32 v104, 0, v104, s[58:59]
    v_cndmask_b32 v105, 0, v105, s[58:59]
    v_cndmask_b32 v106, 0, v106, s[58:59]
    v_cndmask_b32 v107, 0, v107, s[58:59]
    v_cndmask_b32 v108, 0, v108, s[58:59]
    v_cndmask_b32 v109, 0, v109, s[58:59]
    v_cndmask_b32 v110, 0, v110, s[58:59]
    v_cndmask_b32 v111, 0, v111, s[58:59]
    v_cndmask_b32 v112, 0, v112, s[58:59]
    v_cndmask_b32 v113, 0, v113, s[58:59]
    v_cndmask_b32 v114, 0, v114, s[58:59]
    v_cndmask_b32 v115, 0, v115, s[58:59]
    s_and_b32 s12, s4, 1
    s_lshl_b32 s12, s12, 3
    s_lshl_b32 s13, s6, 1
    s_add_u32 s12, s12, s13
    s_add_u32 s12, s12, 0
    s_mul_i32 s12, s12, 3
    s_lshr_b32 s13, s4, 1
    s_add_u32 s10, s12, s13
    s_and_b32 s12, s4, 1
    s_lshl_b32 s12, s12, 3
    s_lshl_b32 s13, s6, 1
    s_add_u32 s12, s12, s13
    s_add_u32 s12, s12, 1
    s_mul_i32 s12, s12, 3
    s_lshr_b32 s13, s4, 1
    s_add_u32 s11, s12, s13
    s_mul_i32 s15, s10, 28
    s_lshl_b32 s12, s5, 1
    s_add_u32 s15, s15, s12
    s_add_u32 s15, s15, 0
    s_lshl_b32 s15, s15, 10
    s_add_u32 s15, s15, 0x100000
    buffer_store_dwordx4 v[100:103], v250, s[36:39], s15 offen sc1
    s_mul_i32 s15, s10, 28
    s_lshl_b32 s12, s5, 1
    s_add_u32 s15, s15, s12
    s_add_u32 s15, s15, 1
    s_lshl_b32 s15, s15, 10
    s_add_u32 s15, s15, 0x100000
    buffer_store_dwordx4 v[104:107], v250, s[36:39], s15 offen sc1
    s_mul_i32 s15, s11, 28
    s_lshl_b32 s12, s5, 1
    s_add_u32 s15, s15, s12
    s_add_u32 s15, s15, 0
    s_lshl_b32 s15, s15, 10
    s_add_u32 s15, s15, 0x100000
    buffer_store_dwordx4 v[108:111], v250, s[36:39], s15 offen sc1
    s_mul_i32 s15, s11, 28
    s_lshl_b32 s12, s5, 1
    s_add_u32 s15, s15, s12
    s_add_u32 s15, s15, 1
    s_lshl_b32 s15, s15, 10
    s_add_u32 s15, s15, 0x100000
    buffer_store_dwordx4 v[112:115], v250, s[36:39], s15 offen sc1
    s_endpgm
K1_P:
    s_mov_b32 s3, s2
    v_lshlrev_b32 v4, 7, v0
    v_mov_b32 v5, 0
    v_cmp_gt_u32 vcc, 16, v0
    v_mov_b32 v6, 0x40000000
    s_nop 0
    v_cndmask_b32 v4, v6, v4, vcc
    s_mov_b32 s4, 0x1a80000
    buffer_store_dword v5, v4, s[36:39], s4 offen
    s_mov_b32 s40, s28
    s_mov_b32 s41, s29
    s_mov_b32 s42, 0x380
    s_mov_b32 s43, 0x00020000
    s_mov_b32 s44, s30
    s_mov_b32 s45, s31
    s_mov_b32 s46, 0x24c000
    s_mov_b32 s47, 0x00020000
    s_mul_i32 s4, s3, 43
    s_lshr_b32 s4, s4, 8
    s_mul_i32 s5, s4, 6
    s_sub_u32 s5, s3, s5
    v_lshrrev_b32 v8, 6, v0
    s_nop 0
    v_readfirstlane_b32 s6, v8
    v_and_b32 v1, 63, v0
    s_mul_i32 s7, s4, 56
    s_mul_i32 s8, s6, 14
    s_add_u32 s7, s7, s8
    v_mov_b32 v4, 0
    s_lshl_b32 s9, s7, 1
    buffer_load_dword v10, v4, s[40:43], s9 offen offset:0
    buffer_load_dword v11, v4, s[40:43], s9 offen offset:4
    buffer_load_dword v12, v4, s[40:43], s9 offen offset:8
    buffer_load_dword v13, v4, s[40:43], s9 offen offset:12
    buffer_load_dword v14, v4, s[40:43], s9 offen offset:16
    buffer_load_dword v15, v4, s[40:43], s9 offen offset:20
    buffer_load_dword v16, v4, s[40:43], s9 offen offset:24
    s_lshl_b32 s10, s5, 10
    v_lshlrev_b32 v5, 4, v1
    v_add_u32 v5, s10, v5
    v_cmp_gt_u32 vcc, 5376, v5
    v_mov_b32 v6, 0x40000000
    s_nop 0
    v_cndmask_b32 v5, v6, v5, vcc
    s_mul_i32 s8, s7, 5376
    buffer_load_dwordx4 v[24:27], v5, s[44:47], s8 offen
    s_add_u32 s8, s8, 5376
    buffer_load_dwordx4 v[28:31], v5, s[44:47], s8 offen
    s_add_u32 s8, s8, 5376
    buffer_load_dwordx4 v[32:35], v5, s[44:47], s8 offen
    s_add_u32 s8, s8, 5376
    buffer_load_dwordx4 v[36:39], v5, s[44:47], s8 offen
    s_add_u32 s8, s8, 5376
    buffer_load_dwordx4 v[40:43], v5, s[44:47], s8 offen
    s_add_u32 s8, s8, 5376
    buffer_load_dwordx4 v[44:47], v5, s[44:47], s8 offen
    s_add_u32 s8, s8, 5376
    buffer_load_dwordx4 v[48:51], v5, s[44:47], s8 offen
    s_add_u32 s8, s8, 5376
    buffer_load_dwordx4 v[52:55], v5, s[44:47], s8 offen
    s_add_u32 s8, s8, 5376
    buffer_load_dwordx4 v[56:59], v5, s[44:47], s8 offen
    s_add_u32 s8, s8, 5376
    buffer_load_dwordx4 v[60:63], v5, s[44:47], s8 offen
    s_add_u32 s8, s8, 5376
    buffer_load_dwordx4 v[64:67], v5, s[44:47], s8 offen
    s_add_u32 s8, s8, 5376
    buffer_load_dwordx4 v[68:71], v5, s[44:47], s8 offen
    s_add_u32 s8, s8, 5376
    buffer_load_dwordx4 v[72:75], v5, s[44:47], s8 offen
    s_add_u32 s8, s8, 5376
    buffer_load_dwordx4 v[76:79], v5, s[44:47], s8 offen
    s_waitcnt vmcnt(14)
    s_mov_b32 s51, 0xbfb8aa3b
    v_lshlrev_b32 v80, 16, v10
    v_and_b32 v81, 0xffff0000, v10
    v_lshlrev_b32 v82, 16, v11
    v_and_b32 v83, 0xffff0000, v11
    v_lshlrev_b32 v84, 16, v12
    v_and_b32 v85, 0xffff0000, v12
    v_lshlrev_b32 v86, 16, v13
    v_and_b32 v87, 0xffff0000, v13
    v_lshlrev_b32 v88, 16, v14
    v_and_b32 v89, 0xffff0000, v14
    v_lshlrev_b32 v90, 16, v15
    v_and_b32 v91, 0xffff0000, v15
    v_lshlrev_b32 v92, 16, v16
    v_and_b32 v93, 0xffff0000, v16
    v_mul_f32 v100, s51, v80
    v_mul_f32 v101, s51, v81
    v_mul_f32 v102, s51, v82
    v_mul_f32 v103, s51, v83
    v_mul_f32 v104, s51, v84
    v_mul_f32 v105, s51, v85
    v_mul_f32 v106, s51, v86
    v_mul_f32 v107, s51, v87
    v_mul_f32 v108, s51, v88
    v_mul_f32 v109, s51, v89
    v_mul_f32 v110, s51, v90
    v_mul_f32 v111, s51, v91
    v_mul_f32 v112, s51, v92
    v_mul_f32 v113, s51, v93
    v_exp_f32 v100, v100
    v_exp_f32 v101, v101
    v_exp_f32 v102, v102
    v_exp_f32 v103, v103
    v_exp_f32 v104, v104
    v_exp_f32 v105, v105
    v_exp_f32 v106, v106
    v_exp_f32 v107, v107
    v_exp_f32 v108, v108
    v_exp_f32 v109, v109
    v_exp_f32 v110, v110
    v_exp_f32 v111, v111
    v_exp_f32 v112, v112
    v_exp_f32 v113, v113
    v_add_f32 v100, 1.0, v100
    v_add_f32 v101, 1.0, v101
    v_add_f32 v102, 1.0, v102
    v_add_f32 v103, 1.0, v103
    v_add_f32 v104, 1.0, v104
    v_add_f32 v105, 1.0, v105
    v_add_f32 v106, 1.0, v106
    v_add_f32 v107, 1.0, v107
    v_add_f32 v108, 1.0, v108
    v_add_f32 v109, 1.0, v109
    v_add_f32 v110, 1.0, v110
    v_add_f32 v111, 1.0, v111
    v_add_f32 v112, 1.0, v112
    v_add_f32 v113, 1.0, v113
    v_rcp_f32 v100, v100
    v_rcp_f32 v101, v101
    v_rcp_f32 v102, v102
    v_rcp_f32 v103, v103
    v_rcp_f32 v104, v104
    v_rcp_f32 v105, v105
    v_rcp_f32 v106, v106
    v_rcp_f32 v107, v107
    v_rcp_f32 v108, v108
    v_rcp_f32 v109, v109
    v_rcp_f32 v110, v110
    v_rcp_f32 v111, v111
    v_rcp_f32 v112, v112
    v_rcp_f32 v113, v113
    v_mul_f32 v80, v80, v100
    v_mul_f32 v81, v81, v101
    v_mul_f32 v82, v82, v102
    v_mul_f32 v83, v83, v103
    v_mul_f32 v84, v84, v104
    v_mul_f32 v85, v85, v105
    v_mul_f32 v86, v86, v106
    v_mul_f32 v87, v87, v107
    v_mul_f32 v88, v88, v108
    v_mul_f32 v89, v89, v109
    v_mul_f32 v90, v90, v110
    v_mul_f32 v91, v91, v111
    v_mul_f32 v92, v92, v112
    v_mul_f32 v93, v93, v113
    v_cvt_pk_bf16_f32 v100, v80, v81
    v_cvt_pk_bf16_f32 v101, v82, v83
    v_cvt_pk_bf16_f32 v102, v84, v85
    v_cvt_pk_bf16_f32 v103, v86, v87
    v_cvt_pk_bf16_f32 v104, v88, v89
    v_cvt_pk_bf16_f32 v105, v90, v91
    v_cvt_pk_bf16_f32 v106, v92, v93
    v_lshlrev_b32 v80, 16, v100
    v_and_b32 v81, 0xffff0000, v100
    v_lshlrev_b32 v82, 16, v101
    v_and_b32 v83, 0xffff0000, v101
    v_lshlrev_b32 v84, 16, v102
    v_and_b32 v85, 0xffff0000, v102
    v_lshlrev_b32 v86, 16, v103
    v_and_b32 v87, 0xffff0000, v103
    v_lshlrev_b32 v88, 16, v104
    v_and_b32 v89, 0xffff0000, v104
    v_lshlrev_b32 v90, 16, v105
    v_and_b32 v91, 0xffff0000, v105
    v_lshlrev_b32 v92, 16, v106
    v_and_b32 v93, 0xffff0000, v106
    v_mov_b32 v100, 0
    v_mov_b32 v101, 0
    v_mov_b32 v102, 0
    v_mov_b32 v103, 0
    v_mov_b32 v104, 0
    v_mov_b32 v105, 0
    v_mov_b32 v106, 0
    v_mov_b32 v107, 0
    s_waitcnt vmcnt(13)
    v_lshlrev_b32 v110, 16, v24
    v_and_b32 v111, 0xffff0000, v24
    v_lshlrev_b32 v112, 16, v25
    v_and_b32 v113, 0xffff0000, v25
    v_lshlrev_b32 v114, 16, v26
    v_and_b32 v115, 0xffff0000, v26
    v_lshlrev_b32 v116, 16, v27
    v_and_b32 v117, 0xffff0000, v27
    v_fmac_f32 v100, v80, v110
    v_fmac_f32 v101, v80, v111
    v_fmac_f32 v102, v80, v112
    v_fmac_f32 v103, v80, v113
    v_fmac_f32 v104, v80, v114
    v_fmac_f32 v105, v80, v115
    v_fmac_f32 v106, v80, v116
    v_fmac_f32 v107, v80, v117
    s_waitcnt vmcnt(12)
    v_lshlrev_b32 v118, 16, v28
    v_and_b32 v119, 0xffff0000, v28
    v_lshlrev_b32 v120, 16, v29
    v_and_b32 v121, 0xffff0000, v29
    v_lshlrev_b32 v122, 16, v30
    v_and_b32 v123, 0xffff0000, v30
    v_lshlrev_b32 v124, 16, v31
    v_and_b32 v125, 0xffff0000, v31
    v_fmac_f32 v100, v81, v118
    v_fmac_f32 v101, v81, v119
    v_fmac_f32 v102, v81, v120
    v_fmac_f32 v103, v81, v121
    v_fmac_f32 v104, v81, v122
    v_fmac_f32 v105, v81, v123
    v_fmac_f32 v106, v81, v124
    v_fmac_f32 v107, v81, v125
    s_waitcnt vmcnt(11)
    v_lshlrev_b32 v110, 16, v32
    v_and_b32 v111, 0xffff0000, v32
    v_lshlrev_b32 v112, 16, v33
    v_and_b32 v113, 0xffff0000, v33
    v_lshlrev_b32 v114, 16, v34
    v_and_b32 v115, 0xffff0000, v34
    v_lshlrev_b32 v116, 16, v35
    v_and_b32 v117, 0xffff0000, v35
    v_fmac_f32 v100, v82, v110
    v_fmac_f32 v101, v82, v111
    v_fmac_f32 v102, v82, v112
    v_fmac_f32 v103, v82, v113
    v_fmac_f32 v104, v82, v114
    v_fmac_f32 v105, v82, v115
    v_fmac_f32 v106, v82, v116
    v_fmac_f32 v107, v82, v117
    s_waitcnt vmcnt(10)
    v_lshlrev_b32 v118, 16, v36
    v_and_b32 v119, 0xffff0000, v36
    v_lshlrev_b32 v120, 16, v37
    v_and_b32 v121, 0xffff0000, v37
    v_lshlrev_b32 v122, 16, v38
    v_and_b32 v123, 0xffff0000, v38
    v_lshlrev_b32 v124, 16, v39
    v_and_b32 v125, 0xffff0000, v39
    v_fmac_f32 v100, v83, v118
    v_fmac_f32 v101, v83, v119
    v_fmac_f32 v102, v83, v120
    v_fmac_f32 v103, v83, v121
    v_fmac_f32 v104, v83, v122
    v_fmac_f32 v105, v83, v123
    v_fmac_f32 v106, v83, v124
    v_fmac_f32 v107, v83, v125
    s_waitcnt vmcnt(9)
    v_lshlrev_b32 v110, 16, v40
    v_and_b32 v111, 0xffff0000, v40
    v_lshlrev_b32 v112, 16, v41
    v_and_b32 v113, 0xffff0000, v41
    v_lshlrev_b32 v114, 16, v42
    v_and_b32 v115, 0xffff0000, v42
    v_lshlrev_b32 v116, 16, v43
    v_and_b32 v117, 0xffff0000, v43
    v_fmac_f32 v100, v84, v110
    v_fmac_f32 v101, v84, v111
    v_fmac_f32 v102, v84, v112
    v_fmac_f32 v103, v84, v113
    v_fmac_f32 v104, v84, v114
    v_fmac_f32 v105, v84, v115
    v_fmac_f32 v106, v84, v116
    v_fmac_f32 v107, v84, v117
    s_waitcnt vmcnt(8)
    v_lshlrev_b32 v118, 16, v44
    v_and_b32 v119, 0xffff0000, v44
    v_lshlrev_b32 v120, 16, v45
    v_and_b32 v121, 0xffff0000, v45
    v_lshlrev_b32 v122, 16, v46
    v_and_b32 v123, 0xffff0000, v46
    v_lshlrev_b32 v124, 16, v47
    v_and_b32 v125, 0xffff0000, v47
    v_fmac_f32 v100, v85, v118
    v_fmac_f32 v101, v85, v119
    v_fmac_f32 v102, v85, v120
    v_fmac_f32 v103, v85, v121
    v_fmac_f32 v104, v85, v122
    v_fmac_f32 v105, v85, v123
    v_fmac_f32 v106, v85, v124
    v_fmac_f32 v107, v85, v125
    s_waitcnt vmcnt(7)
    v_lshlrev_b32 v110, 16, v48
    v_and_b32 v111, 0xffff0000, v48
    v_lshlrev_b32 v112, 16, v49
    v_and_b32 v113, 0xffff0000, v49
    v_lshlrev_b32 v114, 16, v50
    v_and_b32 v115, 0xffff0000, v50
    v_lshlrev_b32 v116, 16, v51
    v_and_b32 v117, 0xffff0000, v51
    v_fmac_f32 v100, v86, v110
    v_fmac_f32 v101, v86, v111
    v_fmac_f32 v102, v86, v112
    v_fmac_f32 v103, v86, v113
    v_fmac_f32 v104, v86, v114
    v_fmac_f32 v105, v86, v115
    v_fmac_f32 v106, v86, v116
    v_fmac_f32 v107, v86, v117
    s_waitcnt vmcnt(6)
    v_lshlrev_b32 v118, 16, v52
    v_and_b32 v119, 0xffff0000, v52
    v_lshlrev_b32 v120, 16, v53
    v_and_b32 v121, 0xffff0000, v53
    v_lshlrev_b32 v122, 16, v54
    v_and_b32 v123, 0xffff0000, v54
    v_lshlrev_b32 v124, 16, v55
    v_and_b32 v125, 0xffff0000, v55
    v_fmac_f32 v100, v87, v118
    v_fmac_f32 v101, v87, v119
    v_fmac_f32 v102, v87, v120
    v_fmac_f32 v103, v87, v121
    v_fmac_f32 v104, v87, v122
    v_fmac_f32 v105, v87, v123
    v_fmac_f32 v106, v87, v124
    v_fmac_f32 v107, v87, v125
    s_waitcnt vmcnt(5)
    v_lshlrev_b32 v110, 16, v56
    v_and_b32 v111, 0xffff0000, v56
    v_lshlrev_b32 v112, 16, v57
    v_and_b32 v113, 0xffff0000, v57
    v_lshlrev_b32 v114, 16, v58
    v_and_b32 v115, 0xffff0000, v58
    v_lshlrev_b32 v116, 16, v59
    v_and_b32 v117, 0xffff0000, v59
    v_fmac_f32 v100, v88, v110
    v_fmac_f32 v101, v88, v111
    v_fmac_f32 v102, v88, v112
    v_fmac_f32 v103, v88, v113
    v_fmac_f32 v104, v88, v114
    v_fmac_f32 v105, v88, v115
    v_fmac_f32 v106, v88, v116
    v_fmac_f32 v107, v88, v117
    s_waitcnt vmcnt(4)
    v_lshlrev_b32 v118, 16, v60
    v_and_b32 v119, 0xffff0000, v60
    v_lshlrev_b32 v120, 16, v61
    v_and_b32 v121, 0xffff0000, v61
    v_lshlrev_b32 v122, 16, v62
    v_and_b32 v123, 0xffff0000, v62
    v_lshlrev_b32 v124, 16, v63
    v_and_b32 v125, 0xffff0000, v63
    v_fmac_f32 v100, v89, v118
    v_fmac_f32 v101, v89, v119
    v_fmac_f32 v102, v89, v120
    v_fmac_f32 v103, v89, v121
    v_fmac_f32 v104, v89, v122
    v_fmac_f32 v105, v89, v123
    v_fmac_f32 v106, v89, v124
    v_fmac_f32 v107, v89, v125
    s_waitcnt vmcnt(3)
    v_lshlrev_b32 v110, 16, v64
    v_and_b32 v111, 0xffff0000, v64
    v_lshlrev_b32 v112, 16, v65
    v_and_b32 v113, 0xffff0000, v65
    v_lshlrev_b32 v114, 16, v66
    v_and_b32 v115, 0xffff0000, v66
    v_lshlrev_b32 v116, 16, v67
    v_and_b32 v117, 0xffff0000, v67
    v_fmac_f32 v100, v90, v110
    v_fmac_f32 v101, v90, v111
    v_fmac_f32 v102, v90, v112
    v_fmac_f32 v103, v90, v113
    v_fmac_f32 v104, v90, v114
    v_fmac_f32 v105, v90, v115
    v_fmac_f32 v106, v90, v116
    v_fmac_f32 v107, v90, v117
    s_waitcnt vmcnt(2)
    v_lshlrev_b32 v118, 16, v68
    v_and_b32 v119, 0xffff0000, v68
    v_lshlrev_b32 v120, 16, v69
    v_and_b32 v121, 0xffff0000, v69
    v_lshlrev_b32 v122, 16, v70
    v_and_b32 v123, 0xffff0000, v70
    v_lshlrev_b32 v124, 16, v71
    v_and_b32 v125, 0xffff0000, v71
    v_fmac_f32 v100, v91, v118
    v_fmac_f32 v101, v91, v119
    v_fmac_f32 v102, v91, v120
    v_fmac_f32 v103, v91, v121
    v_fmac_f32 v104, v91, v122
    v_fmac_f32 v105, v91, v123
    v_fmac_f32 v106, v91, v124
    v_fmac_f32 v107, v91, v125
    s_waitcnt vmcnt(1)
    v_lshlrev_b32 v110, 16, v72
    v_and_b32 v111, 0xffff0000, v72
    v_lshlrev_b32 v112, 16, v73
    v_and_b32 v113, 0xffff0000, v73
    v_lshlrev_b32 v114, 16, v74
    v_and_b32 v115, 0xffff0000, v74
    v_lshlrev_b32 v116, 16, v75
    v_and_b32 v117, 0xffff0000, v75
    v_fmac_f32 v100, v92, v110
    v_fmac_f32 v101, v92, v111
    v_fmac_f32 v102, v92, v112
    v_fmac_f32 v103, v92, v113
    v_fmac_f32 v104, v92, v114
    v_fmac_f32 v105, v92, v115
    v_fmac_f32 v106, v92, v116
    v_fmac_f32 v107, v92, v117
    s_waitcnt vmcnt(0)
    v_lshlrev_b32 v118, 16, v76
    v_and_b32 v119, 0xffff0000, v76
    v_lshlrev_b32 v120, 16, v77
    v_and_b32 v121, 0xffff0000, v77
    v_lshlrev_b32 v122, 16, v78
    v_and_b32 v123, 0xffff0000, v78
    v_lshlrev_b32 v124, 16, v79
    v_and_b32 v125, 0xffff0000, v79
    v_fmac_f32 v100, v93, v118
    v_fmac_f32 v101, v93, v119
    v_fmac_f32 v102, v93, v120
    v_fmac_f32 v103, v93, v121
    v_fmac_f32 v104, v93, v122
    v_fmac_f32 v105, v93, v123
    v_fmac_f32 v106, v93, v124
    v_fmac_f32 v107, v93, v125
    v_lshlrev_b32 v4, 5, v0
    ds_write_b128 v4, v[100:103]
    ds_write_b128 v4, v[104:107] offset:16
    s_waitcnt lgkmcnt(0)
    s_barrier
    v_lshlrev_b32 v4, 3, v0
    ds_read_b64 v[20:21], v4 offset:0
    ds_read_b64 v[22:23], v4 offset:2048
    ds_read_b64 v[24:25], v4 offset:4096
    ds_read_b64 v[26:27], v4 offset:6144
    s_lshl_b32 s10, s5, 11
    v_add_u32 v5, s10, v4
    v_cmp_gt_u32 vcc, 10752, v5
    s_nop 1
    v_cndmask_b32 v5, v6, v5, vcc
    s_mul_i32 s8, s4, 10752
    s_add_u32 s8, s8, 0x1a00000
    s_waitcnt lgkmcnt(0)
    v_add_f32 v20, v20, v22
    v_add_f32 v24, v24, v26
    v_add_f32 v20, v20, v24
    v_add_f32 v21, v21, v23
    v_add_f32 v25, v25, v27
    v_add_f32 v21, v21, v25
    buffer_store_dwordx2 v[20:21], v5, s[36:39], s8 offen
    s_endpgm
K1_WO:
    s_sub_u32 s3, s2, 196
    v_lshrrev_b32 v8, 6, v0
    s_nop 0
    v_readfirstlane_b32 s6, v8
    v_and_b32 v1, 63, v0
    v_bfe_u32 v3, v0, 5, 1
    v_lshlrev_b32 v6, 4, v1
    s_mov_b32 s48, s20
    s_mov_b32 s49, s21
    s_mov_b32 s50, 0x62000
    s_mov_b32 s51, 0x00020000
    s_mul_i32 s8, s3, 28
    s_mul_i32 s9, s6, 7
    s_add_u32 s8, s8, s9
    s_mul_i32 s8, s8, 896
    s_lshl_b32 s9, s9, 10
    s_mov_b32 m0, s9
    s_nop 0
    buffer_load_dwordx4 v6, s[48:51], s8 offen lds
    s_add_u32 s8, s8, 896
    s_add_u32 s9, s9, 1024
    s_mov_b32 m0, s9
    s_nop 0
    buffer_load_dwordx4 v6, s[48:51], s8 offen lds
    s_add_u32 s8, s8, 896
    s_add_u32 s9, s9, 1024
    s_mov_b32 m0, s9
    s_nop 0
    buffer_load_dwordx4 v6, s[48:51], s8 offen lds
    s_add_u32 s8, s8, 896
    s_add_u32 s9, s9, 1024
    s_mov_b32 m0, s9
    s_nop 0
    buffer_load_dwordx4 v6, s[48:51], s8 offen lds
    s_add_u32 s8, s8, 896
    s_add_u32 s9, s9, 1024
    s_mov_b32 m0, s9
    s_nop 0
    buffer_load_dwordx4 v6, s[48:51], s8 offen lds
    s_add_u32 s8, s8, 896
    s_add_u32 s9, s9, 1024
    s_mov_b32 m0, s9
    s_nop 0
    buffer_load_dwordx4 v6, s[48:51], s8 offen lds
    s_add_u32 s8, s8, 896
    s_add_u32 s9, s9, 1024
    s_mov_b32 m0, s9
    s_nop 0
    buffer_load_dwordx4 v6, s[48:51], s8 offen lds
    v_bfe_u32 v8, v0, 2, 2
    v_bfe_u32 v9, v0, 5, 1
    v_mad_u32_u24 v8, v9, 4, v8
    v_mul_u32_u24 v5, 1024, v8
    v_and_b32 v8, 3, v0
    v_lshl_add_u32 v5, v8, 3, v5
    v_bfe_u32 v8, v0, 4, 1
    v_lshl_add_u32 v5, v8, 5, v5
    v_cmp_eq_u32 s[58:59], 0, v3
    s_waitcnt vmcnt(0)
    s_barrier
    s_cmp_lg_u32 s6, 0
    s_cbranch_scc1 K1_PL_wo_0
    ds_read_b64_tr_b16 v[16:17], v5 offset:0
    ds_read_b64_tr_b16 v[18:19], v5 offset:8192
    ds_read_b64_tr_b16 v[20:21], v5 offset:16384
    ds_read_b64_tr_b16 v[22:23], v5 offset:24576
    ds_read_b64_tr_b16 v[24:25], v5 offset:64
    ds_read_b64_tr_b16 v[26:27], v5 offset:8256
    ds_read_b64_tr_b16 v[28:29], v5 offset:16448
    ds_read_b64_tr_b16 v[30:31], v5 offset:24640
    ds_read_b64_tr_b16 v[32:33], v5 offset:128
    ds_read_b64_tr_b16 v[34:35], v5 offset:8320
    ds_read_b64_tr_b16 v[36:37], v5 offset:16512
    ds_read_b64_tr_b16 v[38:39], v5 offset:24704
    ds_read_b64_tr_b16 v[40:41], v5 offset:192
    ds_read_b64_tr_b16 v[42:43], v5 offset:8384
    s_waitcnt lgkmcnt(0)
    s_lshl_b32 s10, s3, 11
    s_add_u32 s10, s10, 0x280000
    buffer_store_dwordx4 v[16:19], v6, s[36:39], s10 offen sc1
    v_cndmask_b32 v22, 0, v22, s[58:59]
    v_cndmask_b32 v23, 0, v23, s[58:59]
    s_lshl_b32 s10, s3, 11
    s_add_u32 s10, s10, 0x280400
    buffer_store_dwordx4 v[20:23], v6, s[36:39], s10 offen sc1
    s_lshl_b32 s10, s3, 11
    s_add_u32 s10, s10, 0x288000
    buffer_store_dwordx4 v[24:27], v6, s[36:39], s10 offen sc1
    v_cndmask_b32 v30, 0, v30, s[58:59]
    v_cndmask_b32 v31, 0, v31, s[58:59]
    s_lshl_b32 s10, s3, 11
    s_add_u32 s10, s10, 0x288400
    buffer_store_dwordx4 v[28:31], v6, s[36:39], s10 offen sc1
    s_lshl_b32 s10, s3, 11
    s_add_u32 s10, s10, 0x290000
    buffer_store_dwordx4 v[32:35], v6, s[36:39], s10 offen sc1
    v_cndmask_b32 v38, 0, v38, s[58:59]
    v_cndmask_b32 v39, 0, v39, s[58:59]
    s_lshl_b32 s10, s3, 11
    s_add_u32 s10, s10, 0x290400
    buffer_store_dwordx4 v[36:39], v6, s[36:39], s10 offen sc1
    s_lshl_b32 s10, s3, 11
    s_add_u32 s10, s10, 0x298000
    buffer_store_dwordx4 v[40:43], v6, s[36:39], s10 offen sc1
    s_endpgm
K1_PL_wo_0:
    s_cmp_lg_u32 s6, 1
    s_cbranch_scc1 K1_PL_wo_1
    ds_read_b64_tr_b16 v[16:17], v5 offset:16576
    ds_read_b64_tr_b16 v[18:19], v5 offset:24768
    ds_read_b64_tr_b16 v[20:21], v5 offset:256
    ds_read_b64_tr_b16 v[22:23], v5 offset:8448
    ds_read_b64_tr_b16 v[24:25], v5 offset:16640
    ds_read_b64_tr_b16 v[26:27], v5 offset:24832
    ds_read_b64_tr_b16 v[28:29], v5 offset:320
    ds_read_b64_tr_b16 v[30:31], v5 offset:8512
    ds_read_b64_tr_b16 v[32:33], v5 offset:16704
    ds_read_b64_tr_b16 v[34:35], v5 offset:24896
    ds_read_b64_tr_b16 v[36:37], v5 offset:384
    ds_read_b64_tr_b16 v[38:39], v5 offset:8576
    ds_read_b64_tr_b16 v[40:41], v5 offset:16768
    ds_read_b64_tr_b16 v[42:43], v5 offset:24960
    s_waitcnt lgkmcnt(0)
    v_cndmask_b32 v18, 0, v18, s[58:59]
    v_cndmask_b32 v19, 0, v19, s[58:59]
    s_lshl_b32 s10, s3, 11
    s_add_u32 s10, s10, 0x298400
    buffer_store_dwordx4 v[16:19], v6, s[36:39], s10 offen sc1
    s_lshl_b32 s10, s3, 11
    s_add_u32 s10, s10, 0x2a0000
    buffer_store_dwordx4 v[20:23], v6, s[36:39], s10 offen sc1
    v_cndmask_b32 v26, 0, v26, s[58:59]
    v_cndmask_b32 v27, 0, v27, s[58:59]
    s_lshl_b32 s10, s3, 11
    s_add_u32 s10, s10, 0x2a0400
    buffer_store_dwordx4 v[24:27], v6, s[36:39], s10 offen sc1
    s_lshl_b32 s10, s3, 11
    s_add_u32 s10, s10, 0x2a8000
    buffer_store_dwordx4 v[28:31], v6, s[36:39], s10 offen sc1
    v_cndmask_b32 v34, 0, v34, s[58:59]
    v_cndmask_b32 v35, 0, v35, s[58:59]
    s_lshl_b32 s10, s3, 11
    s_add_u32 s10, s10, 0x2a8400
    buffer_store_dwordx4 v[32:35], v6, s[36:39], s10 offen sc1
    s_lshl_b32 s10, s3, 11
    s_add_u32 s10, s10, 0x2b0000
    buffer_store_dwordx4 v[36:39], v6, s[36:39], s10 offen sc1
    v_cndmask_b32 v42, 0, v42, s[58:59]
    v_cndmask_b32 v43, 0, v43, s[58:59]
    s_lshl_b32 s10, s3, 11
    s_add_u32 s10, s10, 0x2b0400
    buffer_store_dwordx4 v[40:43], v6, s[36:39], s10 offen sc1
    s_endpgm
K1_PL_wo_1:
    s_cmp_lg_u32 s6, 2
    s_cbranch_scc1 K1_PL_wo_2
    ds_read_b64_tr_b16 v[16:17], v5 offset:448
    ds_read_b64_tr_b16 v[18:19], v5 offset:8640
    ds_read_b64_tr_b16 v[20:21], v5 offset:16832
    ds_read_b64_tr_b16 v[22:23], v5 offset:25024
    ds_read_b64_tr_b16 v[24:25], v5 offset:512
    ds_read_b64_tr_b16 v[26:27], v5 offset:8704
    ds_read_b64_tr_b16 v[28:29], v5 offset:16896
    ds_read_b64_tr_b16 v[30:31], v5 offset:25088
    ds_read_b64_tr_b16 v[32:33], v5 offset:576
    ds_read_b64_tr_b16 v[34:35], v5 offset:8768
    ds_read_b64_tr_b16 v[36:37], v5 offset:16960
    ds_read_b64_tr_b16 v[38:39], v5 offset:25152
    ds_read_b64_tr_b16 v[40:41], v5 offset:640
    ds_read_b64_tr_b16 v[42:43], v5 offset:8832
    s_waitcnt lgkmcnt(0)
    s_lshl_b32 s10, s3, 11
    s_add_u32 s10, s10, 0x2b8000
    buffer_store_dwordx4 v[16:19], v6, s[36:39], s10 offen sc1
    v_cndmask_b32 v22, 0, v22, s[58:59]
    v_cndmask_b32 v23, 0, v23, s[58:59]
    s_lshl_b32 s10, s3, 11
    s_add_u32 s10, s10, 0x2b8400
    buffer_store_dwordx4 v[20:23], v6, s[36:39], s10 offen sc1
    s_lshl_b32 s10, s3, 11
    s_add_u32 s10, s10, 0x2c0000
    buffer_store_dwordx4 v[24:27], v6, s[36:39], s10 offen sc1
    v_cndmask_b32 v30, 0, v30, s[58:59]
    v_cndmask_b32 v31, 0, v31, s[58:59]
    s_lshl_b32 s10, s3, 11
    s_add_u32 s10, s10, 0x2c0400
    buffer_store_dwordx4 v[28:31], v6, s[36:39], s10 offen sc1
    s_lshl_b32 s10, s3, 11
    s_add_u32 s10, s10, 0x2c8000
    buffer_store_dwordx4 v[32:35], v6, s[36:39], s10 offen sc1
    v_cndmask_b32 v38, 0, v38, s[58:59]
    v_cndmask_b32 v39, 0, v39, s[58:59]
    s_lshl_b32 s10, s3, 11
    s_add_u32 s10, s10, 0x2c8400
    buffer_store_dwordx4 v[36:39], v6, s[36:39], s10 offen sc1
    s_lshl_b32 s10, s3, 11
    s_add_u32 s10, s10, 0x2d0000
    buffer_store_dwordx4 v[40:43], v6, s[36:39], s10 offen sc1
    s_endpgm
K1_PL_wo_2:
    s_cmp_lg_u32 s6, 3
    s_cbranch_scc1 K1_PL_wo_3
    ds_read_b64_tr_b16 v[16:17], v5 offset:17024
    ds_read_b64_tr_b16 v[18:19], v5 offset:25216
    ds_read_b64_tr_b16 v[20:21], v5 offset:704
    ds_read_b64_tr_b16 v[22:23], v5 offset:8896
    ds_read_b64_tr_b16 v[24:25], v5 offset:17088
    ds_read_b64_tr_b16 v[26:27], v5 offset:25280
    ds_read_b64_tr_b16 v[28:29], v5 offset:768
    ds_read_b64_tr_b16 v[30:31], v5 offset:8960
    ds_read_b64_tr_b16 v[32:33], v5 offset:17152
    ds_read_b64_tr_b16 v[34:35], v5 offset:25344
    ds_read_b64_tr_b16 v[36:37], v5 offset:832
    ds_read_b64_tr_b16 v[38:39], v5 offset:9024
    ds_read_b64_tr_b16 v[40:41], v5 offset:17216
    ds_read_b64_tr_b16 v[42:43], v5 offset:25408
    s_waitcnt lgkmcnt(0)
    v_cndmask_b32 v18, 0, v18, s[58:59]
    v_cndmask_b32 v19, 0, v19, s[58:59]
    s_lshl_b32 s10, s3, 11
    s_add_u32 s10, s10, 0x2d0400
    buffer_store_dwordx4 v[16:19], v6, s[36:39], s10 offen sc1
    s_lshl_b32 s10, s3, 11
    s_add_u32 s10, s10, 0x2d8000
    buffer_store_dwordx4 v[20:23], v6, s[36:39], s10 offen sc1
    v_cndmask_b32 v26, 0, v26, s[58:59]
    v_cndmask_b32 v27, 0, v27, s[58:59]
    s_lshl_b32 s10, s3, 11
    s_add_u32 s10, s10, 0x2d8400
    buffer_store_dwordx4 v[24:27], v6, s[36:39], s10 offen sc1
    s_lshl_b32 s10, s3, 11
    s_add_u32 s10, s10, 0x2e0000
    buffer_store_dwordx4 v[28:31], v6, s[36:39], s10 offen sc1
    v_cndmask_b32 v34, 0, v34, s[58:59]
    v_cndmask_b32 v35, 0, v35, s[58:59]
    s_lshl_b32 s10, s3, 11
    s_add_u32 s10, s10, 0x2e0400
    buffer_store_dwordx4 v[32:35], v6, s[36:39], s10 offen sc1
    s_lshl_b32 s10, s3, 11
    s_add_u32 s10, s10, 0x2e8000
    buffer_store_dwordx4 v[36:39], v6, s[36:39], s10 offen sc1
    v_cndmask_b32 v42, 0, v42, s[58:59]
    v_cndmask_b32 v43, 0, v43, s[58:59]
    s_lshl_b32 s10, s3, 11
    s_add_u32 s10, s10, 0x2e8400
    buffer_store_dwordx4 v[40:43], v6, s[36:39], s10 offen sc1
    s_endpgm
K1_PL_wo_3:
    s_endpgm
K1_END:
    s_endpgm
.globl qkv_kernel
.p2align 8
.type qkv_kernel,@function
qkv_kernel:
    s_cmp_ge_u32 s2, 256
    s_cbranch_scc1 K2_END
    s_load_dwordx16 s[16:31], s[0:1], 0
    s_load_dwordx2 s[32:33], s[0:1], 64
    s_load_dwordx2 s[34:35], s[0:1], 80
    s_waitcnt lgkmcnt(0)
    s_mov_b32 s36, s34
    s_mov_b32 s37, s35
    s_mov_b32 s38, 0x1b00000
    s_mov_b32 s39, 0x00020000
    v_lshrrev_b32 v8, 6, v0
    s_nop 0
    v_readfirstlane_b32 s6, v8
    v_and_b32 v1, 63, v0
    v_and_b32 v2, 31, v0
    v_bfe_u32 v3, v0, 5, 1
    v_lshlrev_b32 v4, 4, v1
    s_and_b32 s3, s2, 15
    s_lshr_b32 s4, s2, 4
    s_lshl_b32 s5, s3, 2
    s_add_u32 s5, s5, s6
    v_lshlrev_b32 v9, 4, v0
    v_cmp_gt_u32 vcc, 224, v0
    v_mov_b32 v10, 0x40000000
    s_nop 0
    v_cndmask_b32 v10, v10, v9, vcc
    s_mov_b32 s10, 0x1a00000
    buffer_load_dwordx4 v[196:199], v10, s[36:39], s10 offen
    s_add_u32 s10, s10, 10752
    buffer_load_dwordx4 v[200:203], v10, s[36:39], s10 offen
    s_add_u32 s10, s10, 10752
    buffer_load_dwordx4 v[204:207], v10, s[36:39], s10 offen
    s_add_u32 s10, s10, 10752
    buffer_load_dwordx4 v[208:211], v10, s[36:39], s10 offen
    s_add_u32 s10, s10, 10752
    buffer_load_dwordx4 v[212:215], v10, s[36:39], s10 offen
    s_add_u32 s10, s10, 10752
    buffer_load_dwordx4 v[216:219], v10, s[36:39], s10 offen
    s_add_u32 s10, s10, 10752
    buffer_load_dwordx4 v[220:223], v10, s[36:39], s10 offen
    s_add_u32 s10, s10, 10752
    buffer_load_dwordx4 v[224:227], v10, s[36:39], s10 offen
    s_mul_i32 s8, s5, 28672
    s_add_u32 s8, s8, 0x1800000
    s_mul_i32 s12, s4, 86016
    s_lshl_b32 s11, s6, 10
    s_add_u32 s12, s12, s11
    s_add_u32 s12, s12, 0x100000
    s_add_u32 s11, s11, 4096
    buffer_load_dwordx4 v[16:19], v4, s[36:39], s8 offen offset:0
    buffer_load_dwordx4 v[20:23], v4, s[36:39], s8 offen offset:1024
    buffer_load_dwordx4 v[24:27], v4, s[36:39], s8 offen offset:2048
    buffer_load_dwordx4 v[28:31], v4, s[36:39], s8 offen offset:3072
    s_add_u32 s8, s8, 4096
    s_add_u32 s15, s12, 0
    s_mov_b32 m0, s11
    s_nop 0
    buffer_load_dwordx4 v4, s[36:39], s15 offen lds
    s_add_u32 s11, s11, 4096
    s_add_u32 s15, s12, 28672
    s_mov_b32 m0, s11
    s_nop 0
    buffer_load_dwordx4 v4, s[36:39], s15 offen lds
    s_add_u32 s11, s11, 4096
    s_add_u32 s15, s12, 57344
    s_mov_b32 m0, s11
    s_nop 0
    buffer_load_dwordx4 v4, s[36:39], s15 offen lds
    s_add_u32 s11, s11, 4096
    s_add_u32 s12, s12, 4096
    buffer_load_dwordx4 v[32:35], v4, s[36:39], s8 offen offset:0
    buffer_load_dwordx4 v[36:39], v4, s[36:39], s8 offen offset:1024
    buffer_load_dwordx4 v[40:43], v4, s[36:39], s8 offen offset:2048
    buffer_load_dwordx4 v[44:47], v4, s[36:39], s8 offen offset:3072
    s_add_u32 s8, s8, 4096
    s_add_u32 s15, s12, 0
    s_mov_b32 m0, s11
    s_nop 0
    buffer_load_dwordx4 v4, s[36:39], s15 offen lds
    s_add_u32 s11, s11, 4096
    s_add_u32 s15, s12, 28672
    s_mov_b32 m0, s11
    s_nop 0
    buffer_load_dwordx4 v4, s[36:39], s15 offen lds
    s_add_u32 s11, s11, 4096
    s_add_u32 s15, s12, 57344
    s_mov_b32 m0, s11
    s_nop 0
    buffer_load_dwordx4 v4, s[36:39], s15 offen lds
    s_add_u32 s11, s11, 4096
    s_add_u32 s12, s12, 4096
    buffer_load_dwordx4 v[48:51], v4, s[36:39], s8 offen offset:0
    buffer_load_dwordx4 v[52:55], v4, s[36:39], s8 offen offset:1024
    buffer_load_dwordx4 v[56:59], v4, s[36:39], s8 offen offset:2048
    buffer_load_dwordx4 v[60:63], v4, s[36:39], s8 offen offset:3072
    s_add_u32 s8, s8, 4096
    s_add_u32 s15, s12, 0
    s_mov_b32 m0, s11
    s_nop 0
    buffer_load_dwordx4 v4, s[36:39], s15 offen lds
    s_add_u32 s11, s11, 4096
    s_add_u32 s15, s12, 28672
    s_mov_b32 m0, s11
    s_nop 0
    buffer_load_dwordx4 v4, s[36:39], s15 offen lds
    s_add_u32 s11, s11, 4096
    s_add_u32 s15, s12, 57344
    s_mov_b32 m0, s11
    s_nop 0
    buffer_load_dwordx4 v4, s[36:39], s15 offen lds
    s_add_u32 s11, s11, 4096
    s_add_u32 s12, s12, 4096
    buffer_load_dwordx4 v[64:67], v4, s[36:39], s8 offen offset:0
    buffer_load_dwordx4 v[68:71], v4, s[36:39], s8 offen offset:1024
    buffer_load_dwordx4 v[72:75], v4, s[36:39], s8 offen offset:2048
    buffer_load_dwordx4 v[76:79], v4, s[36:39], s8 offen offset:3072
    s_add_u32 s8, s8, 4096
    s_add_u32 s15, s12, 0
    s_mov_b32 m0, s11
    s_nop 0
    buffer_load_dwordx4 v4, s[36:39], s15 offen lds
    s_add_u32 s11, s11, 4096
    s_add_u32 s15, s12, 28672
    s_mov_b32 m0, s11
    s_nop 0
    buffer_load_dwordx4 v4, s[36:39], s15 offen lds
    s_add_u32 s11, s11, 4096
    s_add_u32 s15, s12, 57344
    s_mov_b32 m0, s11
    s_nop 0
    buffer_load_dwordx4 v4, s[36:39], s15 offen lds
    s_add_u32 s11, s11, 4096
    s_add_u32 s12, s12, 4096
    v_lshlrev_b32 v242, 3, v3
    v_sub_u32 v242, v2, v242
    v_mov_b32 v5, 0
    v_cmp_eq_u32 vcc, 0, v242
    v_mov_b32 v243, 0xffff
    s_nop 0
    v_cndmask_b32 v5, v5, v243, vcc
    v_cmp_eq_u32 vcc, 1, v242
    v_mov_b32 v243, 0xffff0000
    s_nop 0
    v_cndmask_b32 v5, v5, v243, vcc
    v_mov_b32 v6, 0
    v_cmp_eq_u32 vcc, 2, v242
    v_mov_b32 v243, 0xffff
    s_nop 0
    v_cndmask_b32 v6, v6, v243, vcc
    v_cmp_eq_u32 vcc, 3, v242
    v_mov_b32 v243, 0xffff0000
    s_nop 0
    v_cndmask_b32 v6, v6, v243, vcc
    v_mov_b32 v7, 0
    v_cmp_eq_u32 vcc, 4, v242
    v_mov_b32 v243, 0xffff
    s_nop 0
    v_cndmask_b32 v7, v7, v243, vcc
    v_cmp_eq_u32 vcc, 5, v242
    v_mov_b32 v243, 0xffff0000
    s_nop 0
    v_cndmask_b32 v7, v7, v243, vcc
    v_mov_b32 v8, 0
    v_cmp_eq_u32 vcc, 6, v242
    v_mov_b32 v243, 0xffff
    s_nop 0
    v_cndmask_b32 v8, v8, v243, vcc
    v_cmp_eq_u32 vcc, 7, v242
    v_mov_b32 v243, 0xffff0000
    s_nop 0
    v_cndmask_b32 v8, v8, v243, vcc
    v_mov_b32 v12, 0
    v_cmp_eq_u32 vcc, 16, v242
    v_mov_b32 v243, 0xffff
    s_nop 0
    v_cndmask_b32 v12, v12, v243, vcc
    v_cmp_eq_u32 vcc, 17, v242
    v_mov_b32 v243, 0xffff0000
    s_nop 0
    v_cndmask_b32 v12, v12, v243, vcc
    v_mov_b32 v13, 0
    v_cmp_eq_u32 vcc, 18, v242
    v_mov_b32 v243, 0xffff
    s_nop 0
    v_cndmask_b32 v13, v13, v243, vcc
    v_cmp_eq_u32 vcc, 19, v242
    v_mov_b32 v243, 0xffff0000
    s_nop 0
    v_cndmask_b32 v13, v13, v243, vcc
    v_mov_b32 v240, 0
    v_cmp_eq_u32 vcc, 20, v242
    v_mov_b32 v243, 0xffff
    s_nop 0
    v_cndmask_b32 v240, v240, v243, vcc
    v_cmp_eq_u32 vcc, 21, v242
    v_mov_b32 v243, 0xffff0000
    s_nop 0
    v_cndmask_b32 v240, v240, v243, vcc
    v_mov_b32 v241, 0
    v_cmp_eq_u32 vcc, 22, v242
    v_mov_b32 v243, 0xffff
    s_nop 0
    v_cndmask_b32 v241, v241, v243, vcc
    v_cmp_eq_u32 vcc, 23, v242
    v_mov_b32 v243, 0xffff0000
    s_nop 0
    v_cndmask_b32 v241, v241, v243, vcc
    s_waitcnt vmcnt(28)
    v_add_f32 v196, v196, v212
    v_add_f32 v197, v197, v213
    v_add_f32 v198, v198, v214
    v_add_f32 v199, v199, v215
    v_add_f32 v200, v200, v216
    v_add_f32 v201, v201, v217
    v_add_f32 v202, v202, v218
    v_add_f32 v203, v203, v219
    v_add_f32 v204, v204, v220
    v_add_f32 v205, v205, v221
    v_add_f32 v206, v206, v222
    v_add_f32 v207, v207, v223
    v_add_f32 v208, v208, v224
    v_add_f32 v209, v209, v225
    v_add_f32 v210, v210, v226
    v_add_f32 v211, v211, v227
    v_add_f32 v196, v196, v204
    v_add_f32 v197, v197, v205
    v_add_f32 v198, v198, v206
    v_add_f32 v199, v199, v207
    v_add_f32 v200, v200, v208
    v_add_f32 v201, v201, v209
    v_add_f32 v202, v202, v210
    v_add_f32 v203, v203, v211
    v_add_f32 v196, v196, v200
    v_add_f32 v197, v197, v201
    v_add_f32 v198, v198, v202
    v_add_f32 v199, v199, v203
    v_cvt_pk_bf16_f32 v200, v196, v197
    v_cvt_pk_bf16_f32 v201, v198, v199
    v_lshlrev_b32 v196, 16, v200
    v_and_b32 v197, 0xffff0000, v200
    v_lshlrev_b32 v198, 16, v201
    v_and_b32 v199, 0xffff0000, v201
    v_add_f32 v200, 1.0, v196
    v_add_f32 v201, 1.0, v197
    v_add_f32 v202, 1.0, v198
    v_add_f32 v203, 1.0, v199
    v_cvt_pk_bf16_f32 v204, v200, v201
    v_cvt_pk_bf16_f32 v205, v202, v203
    v_and_b32 v206, 0xffff, v204
    v_lshl_or_b32 v208, v206, 16, v206
    v_lshrrev_b32 v206, 16, v204
    v_lshl_or_b32 v209, v206, 16, v206
    v_and_b32 v206, 0xffff, v205
    v_lshl_or_b32 v210, v206, 16, v206
    v_lshrrev_b32 v206, 16, v205
    v_lshl_or_b32 v211, v206, 16, v206
    v_cmp_le_u32 vcc, 112, v0
    s_nop 1
    v_cndmask_b32 v196, v196, v208, vcc
    v_cndmask_b32 v197, v197, v209, vcc
    v_cndmask_b32 v198, v198, v210, vcc
    v_cndmask_b32 v199, v199, v211, vcc
    v_add_u32 v206, 256, v9
    v_cndmask_b32 v206, v9, v206, vcc
    v_cmp_gt_u32 vcc, 224, v0
    s_and_saveexec_b64 s[48:49], vcc
    ds_write_b128 v206, v[196:199]
    s_mov_b64 exec, s[48:49]
    v_lshlrev_b32 v9, 2, v2
    v_lshlrev_b32 v11, 4, v3
    v_add_u32 v10, 0xe000, v4
    v_cmp_eq_u32 s[44:45], 1, v3
    v_cmp_eq_u32 s[46:47], 28, v2
    s_lshl_b32 s13, s4, 6
    s_add_u32 s13, s13, s5
    s_lshl_b32 s13, s13, 11
    s_add_u32 s13, s13, 0x700000
    s_mov_b32 s14, 0x3e8b97f6
    s_waitcnt vmcnt(14) lgkmcnt(0)
    s_barrier
    ds_read_b128 v[192:195], v11 offset:0
    ds_read_b128 v[196:199], v11 offset:32
    ds_read_b128 v[200:203], v11 offset:64
    ds_read_b128 v[204:207], v11 offset:96
    ds_read_b32 v242, v9 offset:2048
    ds_read_b128 v[208:211], v11 offset:128
    ds_read_b128 v[212:215], v11 offset:160
    ds_read_b128 v[216:219], v11 offset:192
    ds_read_b128 v[220:223], v11 offset:224
    ds_read_b32 v243, v9 offset:2176
    s_waitcnt lgkmcnt(5)
    v_and_b32 v224, v242, v5
    v_and_b32 v225, v242, v6
    v_and_b32 v226, v242, v7
    v_and_b32 v227, v242, v8
    v_and_b32 v228, v242, v12
    v_and_b32 v229, v242, v13
    v_and_b32 v230, v242, v240
    v_and_b32 v231, v242, v241
    v_mfma_f32_32x32x16_bf16 v[192:207], v[224:227], v[16:19], v[192:207]
    s_nop 0
    v_mfma_f32_32x32x16_bf16 v[192:207], v[228:231], v[20:23], v[192:207]
    s_waitcnt lgkmcnt(0)
    v_and_b32 v232, v243, v5
    v_and_b32 v233, v243, v6
    v_and_b32 v234, v243, v7
    v_and_b32 v235, v243, v8
    v_and_b32 v236, v243, v12
    v_and_b32 v237, v243, v13
    v_and_b32 v238, v243, v240
    v_and_b32 v239, v243, v241
    v_mfma_f32_32x32x16_bf16 v[208:223], v[232:235], v[24:27], v[208:223]
    s_nop 0
    v_mfma_f32_32x32x16_bf16 v[208:223], v[236:239], v[28:31], v[208:223]
    s_nop 7
    v_cvt_pk_bf16_f32 v16, v192, v193
    v_cvt_pk_bf16_f32 v17, v194, v195
    v_cvt_pk_bf16_f32 v18, v196, v197
    v_cvt_pk_bf16_f32 v19, v198, v199
    v_cvt_pk_bf16_f32 v20, v200, v201
    v_cvt_pk_bf16_f32 v21, v202, v203
    v_cvt_pk_bf16_f32 v22, v204, v205
    v_cvt_pk_bf16_f32 v23, v206, v207
    v_cvt_pk_bf16_f32 v24, v208, v209
    v_cvt_pk_bf16_f32 v25, v210, v211
    v_cvt_pk_bf16_f32 v26, v212, v213
    v_cvt_pk_bf16_f32 v27, v214, v215
    v_cvt_pk_bf16_f32 v28, v216, v217
    v_cvt_pk_bf16_f32 v29, v218, v219
    v_cvt_pk_bf16_f32 v30, v220, v221
    v_cvt_pk_bf16_f32 v31, v222, v223
    s_waitcnt vmcnt(14)
    ds_read_b128 v[192:195], v11 offset:256
    ds_read_b128 v[196:199], v11 offset:288
    ds_read_b128 v[200:203], v11 offset:320
    ds_read_b128 v[204:207], v11 offset:352
    ds_read_b32 v242, v9 offset:2304
    ds_read_b128 v[208:211], v11 offset:384
    ds_read_b128 v[212:215], v11 offset:416
    ds_read_b128 v[216:219], v11 offset:448
    ds_read_b128 v[220:223], v11 offset:480
    ds_read_b32 v243, v9 offset:2432
    s_waitcnt lgkmcnt(5)
    v_and_b32 v224, v242, v5
    v_and_b32 v225, v242, v6
    v_and_b32 v226, v242, v7
    v_and_b32 v227, v242, v8
    v_and_b32 v228, v242, v12
    v_and_b32 v229, v242, v13
    v_and_b32 v230, v242, v240
    v_and_b32 v231, v242, v241
    v_mfma_f32_32x32x16_bf16 v[192:207], v[224:227], v[32:35], v[192:207]
    s_nop 0
    v_mfma_f32_32x32x16_bf16 v[192:207], v[228:231], v[36:39], v[192:207]
    s_waitcnt lgkmcnt(0)
    v_and_b32 v232, v243, v5
    v_and_b32 v233, v243, v6
    v_and_b32 v234, v243, v7
    v_and_b32 v235, v243, v8
    v_and_b32 v236, v243, v12
    v_and_b32 v237, v243, v13
    v_and_b32 v238, v243, v240
    v_and_b32 v239, v243, v241
    v_mfma_f32_32x32x16_bf16 v[208:223], v[232:235], v[40:43], v[208:223]
    s_nop 0
    v_mfma_f32_32x32x16_bf16 v[208:223], v[236:239], v[44:47], v[208:223]
    s_nop 7
    v_cvt_pk_bf16_f32 v32, v192, v193
    v_cvt_pk_bf16_f32 v33, v194, v195
    v_cvt_pk_bf16_f32 v34, v196, v197
    v_cvt_pk_bf16_f32 v35, v198, v199
    v_cvt_pk_bf16_f32 v36, v200, v201
    v_cvt_pk_bf16_f32 v37, v202, v203
    v_cvt_pk_bf16_f32 v38, v204, v205
    v_cvt_pk_bf16_f32 v39, v206, v207
    v_cvt_pk_bf16_f32 v40, v208, v209
    v_cvt_pk_bf16_f32 v41, v210, v211
    v_cvt_pk_bf16_f32 v42, v212, v213
    v_cvt_pk_bf16_f32 v43, v214, v215
    v_cvt_pk_bf16_f32 v44, v216, v217
    v_cvt_pk_bf16_f32 v45, v218, v219
    v_cvt_pk_bf16_f32 v46, v220, v221
    v_cvt_pk_bf16_f32 v47, v222, v223
    ds_read_b128 v[176:179], v4 offset:4096
    ds_read_b128 v[180:183], v4 offset:8192
    ds_read_b128 v[184:187], v4 offset:12288
    ds_read_b128 v[188:191], v4 offset:5120
    buffer_load_dwordx4 v[80:83], v4, s[36:39], s8 offen offset:0
    buffer_load_dwordx4 v[84:87], v4, s[36:39], s8 offen offset:1024
    buffer_load_dwordx4 v[88:91], v4, s[36:39], s8 offen offset:2048
    buffer_load_dwordx4 v[92:95], v4, s[36:39], s8 offen offset:3072
    s_add_u32 s8, s8, 4096
    s_add_u32 s15, s12, 0
    s_mov_b32 m0, s11
    s_nop 0
    buffer_load_dwordx4 v4, s[36:39], s15 offen lds
    s_add_u32 s11, s11, 4096
    s_add_u32 s15, s12, 28672
    s_mov_b32 m0, s11
    s_nop 0
    buffer_load_dwordx4 v4, s[36:39], s15 offen lds
    s_add_u32 s11, s11, 4096
    s_add_u32 s15, s12, 57344
    s_mov_b32 m0, s11
    s_nop 0
    buffer_load_dwordx4 v4, s[36:39], s15 offen lds
    s_add_u32 s11, s11, 4096
    s_add_u32 s12, s12, 4096
    s_waitcnt vmcnt(14)
    ds_read_b128 v[244:247], v4 offset:9216
    s_waitcnt lgkmcnt(4)
    v_mfma_f32_32x32x16_bf16 v[128:143], v[176:179], v[16:19], 0
    ds_read_b128 v[192:195], v11 offset:512
    ds_read_b128 v[248:251], v4 offset:13312
    s_waitcnt lgkmcnt(5)
    v_mfma_f32_32x32x16_bf16 v[144:159], v[180:183], v[16:19], 0
    ds_read_b128 v[196:199], v11 offset:544
    ds_read_b128 v[176:179], v4 offset:6144
    s_waitcnt lgkmcnt(6)
    v_mfma_f32_32x32x16_bf16 v[160:175], v[16:19], v[184:187], 0
    ds_read_b128 v[200:203], v11 offset:576
    ds_read_b128 v[180:183], v4 offset:10240
    s_waitcnt lgkmcnt(7)
    v_mfma_f32_32x32x16_bf16 v[128:143], v[188:191], v[20:23], v[128:143]
    ds_read_b128 v[204:207], v11 offset:608
    ds_read_b128 v[184:187], v4 offset:14336
    s_waitcnt lgkmcnt(8)
    v_mfma_f32_32x32x16_bf16 v[144:159], v[244:247], v[20:23], v[144:159]
    ds_read_b32 v242, v9 offset:2560
    ds_read_b128 v[188:191], v4 offset:7168
    s_waitcnt lgkmcnt(8)
    v_mfma_f32_32x32x16_bf16 v[160:175], v[20:23], v[248:251], v[160:175]
    ds_read_b128 v[244:247], v4 offset:11264
    s_waitcnt lgkmcnt(7)
    v_mfma_f32_32x32x16_bf16 v[128:143], v[176:179], v[24:27], v[128:143]
    ds_read_b128 v[208:211], v11 offset:640
    ds_read_b128 v[248:251], v4 offset:15360
    s_waitcnt lgkmcnt(7)
    v_mfma_f32_32x32x16_bf16 v[144:159], v[180:183], v[24:27], v[144:159]
    ds_read_b128 v[212:215], v11 offset:672
    s_barrier
    ds_read_b128 v[176:179], v4 offset:16384
    s_waitcnt lgkmcnt(7)
    v_mfma_f32_32x32x16_bf16 v[160:175], v[24:27], v[184:187], v[160:175]
    ds_read_b128 v[216:219], v11 offset:704
    s_waitcnt lgkmcnt(7)
    v_and_b32 v224, v242, v5
    v_and_b32 v225, v242, v6
    v_and_b32 v226, v242, v7
    v_and_b32 v227, v242, v8
    v_and_b32 v228, v242, v12
    v_and_b32 v229, v242, v13
    v_and_b32 v230, v242, v240
    v_and_b32 v231, v242, v241
    v_mfma_f32_32x32x16_bf16 v[192:207], v[224:227], v[48:51], v[192:207]
    s_nop 0
    v_mfma_f32_32x32x16_bf16 v[192:207], v[228:231], v[52:55], v[192:207]
    ds_read_b128 v[180:183], v4 offset:20480
    s_waitcnt lgkmcnt(7)
    v_mfma_f32_32x32x16_bf16 v[128:143], v[188:191], v[28:31], v[128:143]
    ds_read_b128 v[220:223], v11 offset:736
    ds_read_b128 v[184:187], v4 offset:24576
    s_waitcnt lgkmcnt(8)
    v_mfma_f32_32x32x16_bf16 v[144:159], v[244:247], v[28:31], v[144:159]
    ds_read_b32 v243, v9 offset:2688
    ds_read_b128 v[188:191], v4 offset:17408
    s_waitcnt lgkmcnt(8)
    v_mfma_f32_32x32x16_bf16 v[160:175], v[28:31], v[248:251], v[160:175]
    s_nop 0
    v_cvt_pk_bf16_f32 v48, v192, v193
    v_cvt_pk_bf16_f32 v49, v194, v195
    v_cvt_pk_bf16_f32 v50, v196, v197
    v_cvt_pk_bf16_f32 v51, v198, v199
    v_cvt_pk_bf16_f32 v52, v200, v201
    v_cvt_pk_bf16_f32 v53, v202, v203
    v_cvt_pk_bf16_f32 v54, v204, v205
    v_cvt_pk_bf16_f32 v55, v206, v207
    buffer_load_dwordx4 v[96:99], v4, s[36:39], s8 offen offset:0
    buffer_load_dwordx4 v[100:103], v4, s[36:39], s8 offen offset:1024
    buffer_load_dwordx4 v[104:107], v4, s[36:39], s8 offen offset:2048
    buffer_load_dwordx4 v[108:111], v4, s[36:39], s8 offen offset:3072
    s_add_u32 s8, s8, 4096
    s_add_u32 s15, s12, 0
    s_mov_b32 m0, s11
    s_nop 0
    buffer_load_dwordx4 v4, s[36:39], s15 offen lds
    s_add_u32 s11, s11, 4096
    s_add_u32 s15, s12, 28672
    s_mov_b32 m0, s11
    s_nop 0
    buffer_load_dwordx4 v4, s[36:39], s15 offen lds
    s_add_u32 s11, s11, 4096
    s_add_u32 s15, s12, 57344
    s_mov_b32 m0, s11
    s_nop 0
    buffer_load_dwordx4 v4, s[36:39], s15 offen lds
    s_add_u32 s11, s11, 4096
    s_add_u32 s12, s12, 4096
    s_waitcnt vmcnt(14)
    ds_read_b128 v[244:247], v4 offset:21504
    s_waitcnt lgkmcnt(7)
    v_mfma_f32_32x32x16_bf16 v[128:143], v[176:179], v[32:35], v[128:143]
    ds_read_b128 v[192:195], v11 offset:768
    ds_read_b128 v[248:251], v4 offset:25600
    s_waitcnt lgkmcnt(7)
    v_mfma_f32_32x32x16_bf16 v[144:159], v[180:183], v[32:35], v[144:159]
    ds_read_b128 v[196:199], v11 offset:800
    ds_read_b128 v[176:179], v4 offset:18432
    s_waitcnt lgkmcnt(7)
    v_mfma_f32_32x32x16_bf16 v[160:175], v[32:35], v[184:187], v[160:175]
    s_waitcnt lgkmcnt(6)
    v_and_b32 v232, v243, v5
    v_and_b32 v233, v243, v6
    v_and_b32 v234, v243, v7
    v_and_b32 v235, v243, v8
    v_and_b32 v236, v243, v12
    v_and_b32 v237, v243, v13
    v_and_b32 v238, v243, v240
    v_and_b32 v239, v243, v241
    v_mfma_f32_32x32x16_bf16 v[208:223], v[232:235], v[56:59], v[208:223]
    s_nop 0
    v_mfma_f32_32x32x16_bf16 v[208:223], v[236:239], v[60:63], v[208:223]
    ds_read_b128 v[200:203], v11 offset:832
    ds_read_b128 v[180:183], v4 offset:22528
    s_waitcnt lgkmcnt(7)
    v_mfma_f32_32x32x16_bf16 v[128:143], v[188:191], v[36:39], v[128:143]
    ds_read_b128 v[204:207], v11 offset:864
    ds_read_b128 v[184:187], v4 offset:26624
    s_waitcnt lgkmcnt(8)
    v_mfma_f32_32x32x16_bf16 v[144:159], v[244:247], v[36:39], v[144:159]
    ds_read_b32 v242, v9 offset:2816
    ds_read_b128 v[188:191], v4 offset:19456
    s_waitcnt lgkmcnt(8)
    v_mfma_f32_32x32x16_bf16 v[160:175], v[36:39], v[248:251], v[160:175]
    v_cvt_pk_bf16_f32 v56, v208, v209
    v_cvt_pk_bf16_f32 v57, v210, v211
    v_cvt_pk_bf16_f32 v58, v212, v213
    v_cvt_pk_bf16_f32 v59, v214, v215
    v_cvt_pk_bf16_f32 v60, v216, v217
    v_cvt_pk_bf16_f32 v61, v218, v219
    v_cvt_pk_bf16_f32 v62, v220, v221
    v_cvt_pk_bf16_f32 v63, v222, v223
    ds_read_b128 v[244:247], v4 offset:23552
    s_waitcnt lgkmcnt(7)
    v_mfma_f32_32x32x16_bf16 v[128:143], v[176:179], v[40:43], v[128:143]
    ds_read_b128 v[208:211], v11 offset:896
    ds_read_b128 v[248:251], v4 offset:27648
    s_waitcnt lgkmcnt(7)
    v_mfma_f32_32x32x16_bf16 v[144:159], v[180:183], v[40:43], v[144:159]
    ds_read_b128 v[212:215], v11 offset:928
    s_barrier
    ds_read_b128 v[176:179], v4 offset:28672
    s_waitcnt lgkmcnt(7)
    v_mfma_f32_32x32x16_bf16 v[160:175], v[40:43], v[184:187], v[160:175]
    ds_read_b128 v[216:219], v11 offset:960
    s_waitcnt lgkmcnt(7)
    v_and_b32 v224, v242, v5
    v_and_b32 v225, v242, v6
    v_and_b32 v226, v242, v7
    v_and_b32 v227, v242, v8
    v_and_b32 v228, v242, v12
    v_and_b32 v229, v242, v13
    v_and_b32 v230, v242, v240
    v_and_b32 v231, v242, v241
    v_mfma_f32_32x32x16_bf16 v[192:207], v[224:227], v[64:67], v[192:207]
    s_nop 0
    v_mfma_f32_32x32x16_bf16 v[192:207], v[228:231], v[68:71], v[192:207]
    ds_read_b128 v[180:183], v4 offset:32768
    s_waitcnt lgkmcnt(7)
    v_mfma_f32_32x32x16_bf16 v[128:143], v[188:191], v[44:47], v[128:143]
    ds_read_b128 v[220:223], v11 offset:992
    ds_read_b128 v[184:187], v4 offset:36864
    s_waitcnt lgkmcnt(8)
    v_mfma_f32_32x32x16_bf16 v[144:159], v[244:247], v[44:47], v[144:159]
    ds_read_b32 v243, v9 offset:2944
    ds_read_b128 v[188:191], v4 offset:29696
    s_waitcnt lgkmcnt(8)
    v_mfma_f32_32x32x16_bf16 v[160:175], v[44:47], v[248:251], v[160:175]
    s_nop 0
    v_cvt_pk_bf16_f32 v64, v192, v193
    v_cvt_pk_bf16_f32 v65, v194, v195
    v_cvt_pk_bf16_f32 v66, v196, v197
    v_cvt_pk_bf16_f32 v67, v198, v199
    v_cvt_pk_bf16_f32 v68, v200, v201
    v_cvt_pk_bf16_f32 v69, v202, v203
    v_cvt_pk_bf16_f32 v70, v204, v205
    v_cvt_pk_bf16_f32 v71, v206, v207
    s_sub_u32 s11, s11, 73728
    buffer_load_dwordx4 v[112:115], v4, s[36:39], s8 offen offset:0
    buffer_load_dwordx4 v[116:119], v4, s[36:39], s8 offen offset:1024
    buffer_load_dwordx4 v[120:123], v4, s[36:39], s8 offen offset:2048
    buffer_load_dwordx4 v[124:127], v4, s[36:39], s8 offen offset:3072
    s_add_u32 s8, s8, 4096
    s_add_u32 s15, s12, 0
    s_mov_b32 m0, s11
    s_nop 0
    buffer_load_dwordx4 v4, s[36:39], s15 offen lds
    s_add_u32 s11, s11, 4096
    s_add_u32 s15, s12, 28672
    s_mov_b32 m0, s11
    s_nop 0
    buffer_load_dwordx4 v4, s[36:39], s15 offen lds
    s_add_u32 s11, s11, 4096
    s_add_u32 s15, s12, 57344
    s_mov_b32 m0, s11
    s_nop 0
    buffer_load_dwordx4 v4, s[36:39], s15 offen lds
    s_add_u32 s11, s11, 4096
    s_add_u32 s12, s12, 4096
    s_waitcnt vmcnt(14)
    ds_read_b128 v[244:247], v4 offset:33792
    s_waitcnt lgkmcnt(7)
    v_mfma_f32_32x32x16_bf16 v[128:143], v[176:179], v[48:51], v[128:143]
    ds_read_b128 v[192:195], v11 offset:1024
    ds_read_b128 v[248:251], v4 offset:37888
    s_waitcnt lgkmcnt(7)
    v_mfma_f32_32x32x16_bf16 v[144:159], v[180:183], v[48:51], v[144:159]
    ds_read_b128 v[196:199], v11 offset:1056
    ds_read_b128 v[176:179], v4 offset:30720
    s_waitcnt lgkmcnt(7)
    v_mfma_f32_32x32x16_bf16 v[160:175], v[48:51], v[184:187], v[160:175]
    s_waitcnt lgkmcnt(6)
    v_and_b32 v232, v243, v5
    v_and_b32 v233, v243, v6
    v_and_b32 v234, v243, v7
    v_and_b32 v235, v243, v8
    v_and_b32 v236, v243, v12
    v_and_b32 v237, v243, v13
    v_and_b32 v238, v243, v240
    v_and_b32 v239, v243, v241
    v_mfma_f32_32x32x16_bf16 v[208:223], v[232:235], v[72:75], v[208:223]
    s_nop 0
    v_mfma_f32_32x32x16_bf16 v[208:223], v[236:239], v[76:79], v[208:223]
    ds_read_b128 v[200:203], v11 offset:1088
    ds_read_b128 v[180:183], v4 offset:34816
    s_waitcnt lgkmcnt(7)
    v_mfma_f32_32x32x16_bf16 v[128:143], v[188:191], v[52:55], v[128:143]
    ds_read_b128 v[204:207], v11 offset:1120
    ds_read_b128 v[184:187], v4 offset:38912
    s_waitcnt lgkmcnt(8)
    v_mfma_f32_32x32x16_bf16 v[144:159], v[244:247], v[52:55], v[144:159]
    ds_read_b32 v242, v9 offset:3072
    ds_read_b128 v[188:191], v4 offset:31744
    s_waitcnt lgkmcnt(8)
    v_mfma_f32_32x32x16_bf16 v[160:175], v[52:55], v[248:251], v[160:175]
    v_cvt_pk_bf16_f32 v72, v208, v209
    v_cvt_pk_bf16_f32 v73, v210, v211
    v_cvt_pk_bf16_f32 v74, v212, v213
    v_cvt_pk_bf16_f32 v75, v214, v215
    v_cvt_pk_bf16_f32 v76, v216, v217
    v_cvt_pk_bf16_f32 v77, v218, v219
    v_cvt_pk_bf16_f32 v78, v220, v221
    v_cvt_pk_bf16_f32 v79, v222, v223
    ds_read_b128 v[244:247], v4 offset:35840
    s_waitcnt lgkmcnt(7)
    v_mfma_f32_32x32x16_bf16 v[128:143], v[176:179], v[56:59], v[128:143]
    ds_read_b128 v[208:211], v11 offset:1152
    ds_read_b128 v[248:251], v4 offset:39936
    s_waitcnt lgkmcnt(7)
    v_mfma_f32_32x32x16_bf16 v[144:159], v[180:183], v[56:59], v[144:159]
    ds_read_b128 v[212:215], v11 offset:1184
    s_barrier
    ds_read_b128 v[176:179], v4 offset:40960
    s_waitcnt lgkmcnt(7)
    v_mfma_f32_32x32x16_bf16 v[160:175], v[56:59], v[184:187], v[160:175]
    ds_read_b128 v[216:219], v11 offset:1216
    s_waitcnt lgkmcnt(7)
    v_and_b32 v224, v242, v5
    v_and_b32 v225, v242, v6
    v_and_b32 v226, v242, v7
    v_and_b32 v227, v242, v8
    v_and_b32 v228, v242, v12
    v_and_b32 v229, v242, v13
    v_and_b32 v230, v242, v240
    v_and_b32 v231, v242, v241
    v_mfma_f32_32x32x16_bf16 v[192:207], v[224:227], v[80:83], v[192:207]
    s_nop 0
    v_mfma_f32_32x32x16_bf16 v[192:207], v[228:231], v[84:87], v[192:207]
    ds_read_b128 v[180:183], v4 offset:45056
    s_waitcnt lgkmcnt(7)
    v_mfma_f32_32x32x16_bf16 v[128:143], v[188:191], v[60:63], v[128:143]
    ds_read_b128 v[220:223], v11 offset:1248
    ds_read_b128 v[184:187], v4 offset:49152
    s_waitcnt lgkmcnt(8)
    v_mfma_f32_32x32x16_bf16 v[144:159], v[244:247], v[60:63], v[144:159]
    ds_read_b32 v243, v9 offset:3200
    ds_read_b128 v[188:191], v4 offset:41984
    s_waitcnt lgkmcnt(8)
    v_mfma_f32_32x32x16_bf16 v[160:175], v[60:63], v[248:251], v[160:175]
    s_nop 0
    v_cvt_pk_bf16_f32 v80, v192, v193
    v_cvt_pk_bf16_f32 v81, v194, v195
    v_cvt_pk_bf16_f32 v82, v196, v197
    v_cvt_pk_bf16_f32 v83, v198, v199
    v_cvt_pk_bf16_f32 v84, v200, v201
    v_cvt_pk_bf16_f32 v85, v202, v203
    v_cvt_pk_bf16_f32 v86, v204, v205
    v_cvt_pk_bf16_f32 v87, v206, v207
    s_waitcnt vmcnt(7)
    ds_read_b128 v[244:247], v4 offset:46080
    s_waitcnt lgkmcnt(7)
    v_mfma_f32_32x32x16_bf16 v[128:143], v[176:179], v[64:67], v[128:143]
    ds_read_b128 v[192:195], v11 offset:1280
    ds_read_b128 v[248:251], v4 offset:50176
    s_waitcnt lgkmcnt(7)
    v_mfma_f32_32x32x16_bf16 v[144:159], v[180:183], v[64:67], v[144:159]
    ds_read_b128 v[196:199], v11 offset:1312
    ds_read_b128 v[176:179], v4 offset:43008
    s_waitcnt lgkmcnt(7)
    v_mfma_f32_32x32x16_bf16 v[160:175], v[64:67], v[184:187], v[160:175]
    s_waitcnt lgkmcnt(6)
    v_and_b32 v232, v243, v5
    v_and_b32 v233, v243, v6
    v_and_b32 v234, v243, v7
    v_and_b32 v235, v243, v8
    v_and_b32 v236, v243, v12
    v_and_b32 v237, v243, v13
    v_and_b32 v238, v243, v240
    v_and_b32 v239, v243, v241
    v_mfma_f32_32x32x16_bf16 v[208:223], v[232:235], v[88:91], v[208:223]
    s_nop 0
    v_mfma_f32_32x32x16_bf16 v[208:223], v[236:239], v[92:95], v[208:223]
    ds_read_b128 v[200:203], v11 offset:1344
    ds_read_b128 v[180:183], v4 offset:47104
    s_waitcnt lgkmcnt(7)
    v_mfma_f32_32x32x16_bf16 v[128:143], v[188:191], v[68:71], v[128:143]
    ds_read_b128 v[204:207], v11 offset:1376
    ds_read_b128 v[184:187], v4 offset:51200
    s_waitcnt lgkmcnt(8)
    v_mfma_f32_32x32x16_bf16 v[144:159], v[244:247], v[68:71], v[144:159]
    ds_read_b32 v242, v9 offset:3328
    ds_read_b128 v[188:191], v4 offset:44032
    s_waitcnt lgkmcnt(8)
    v_mfma_f32_32x32x16_bf16 v[160:175], v[68:71], v[248:251], v[160:175]
    v_cvt_pk_bf16_f32 v88, v208, v209
    v_cvt_pk_bf16_f32 v89, v210, v211
    v_cvt_pk_bf16_f32 v90, v212, v213
    v_cvt_pk_bf16_f32 v91, v214, v215
    v_cvt_pk_bf16_f32 v92, v216, v217
    v_cvt_pk_bf16_f32 v93, v218, v219
    v_cvt_pk_bf16_f32 v94, v220, v221
    v_cvt_pk_bf16_f32 v95, v222, v223
    ds_read_b128 v[244:247], v4 offset:48128
    s_waitcnt lgkmcnt(7)
    v_mfma_f32_32x32x16_bf16 v[128:143], v[176:179], v[72:75], v[128:143]
    ds_read_b128 v[208:211], v11 offset:1408
    ds_read_b128 v[248:251], v4 offset:52224
    s_waitcnt lgkmcnt(7)
    v_mfma_f32_32x32x16_bf16 v[144:159], v[180:183], v[72:75], v[144:159]
    ds_read_b128 v[212:215], v11 offset:1440
    s_barrier
    ds_read_b128 v[176:179], v4 offset:53248
    s_waitcnt lgkmcnt(7)
    v_mfma_f32_32x32x16_bf16 v[160:175], v[72:75], v[184:187], v[160:175]
    ds_read_b128 v[216:219], v11 offset:1472
    s_waitcnt lgkmcnt(7)
    v_and_b32 v224, v242, v5
    v_and_b32 v225, v242, v6
    v_and_b32 v226, v242, v7
    v_and_b32 v227, v242, v8
    v_and_b32 v228, v242, v12
    v_and_b32 v229, v242, v13
    v_and_b32 v230, v242, v240
    v_and_b32 v231, v242, v241
    v_mfma_f32_32x32x16_bf16 v[192:207], v[224:227], v[96:99], v[192:207]
    s_nop 0
    v_mfma_f32_32x32x16_bf16 v[192:207], v[228:231], v[100:103], v[192:207]
    ds_read_b128 v[180:183], v10 offset:0
    s_waitcnt lgkmcnt(7)
    v_mfma_f32_32x32x16_bf16 v[128:143], v[188:191], v[76:79], v[128:143]
    ds_read_b128 v[220:223], v11 offset:1504
    ds_read_b128 v[184:187], v10 offset:4096
    s_waitcnt lgkmcnt(8)
    v_mfma_f32_32x32x16_bf16 v[144:159], v[244:247], v[76:79], v[144:159]
    ds_read_b32 v243, v9 offset:3456
    ds_read_b128 v[188:191], v4 offset:54272
    s_waitcnt lgkmcnt(8)
    v_mfma_f32_32x32x16_bf16 v[160:175], v[76:79], v[248:251], v[160:175]
    s_nop 0
    v_cvt_pk_bf16_f32 v96, v192, v193
    v_cvt_pk_bf16_f32 v97, v194, v195
    v_cvt_pk_bf16_f32 v98, v196, v197
    v_cvt_pk_bf16_f32 v99, v198, v199
    v_cvt_pk_bf16_f32 v100, v200, v201
    v_cvt_pk_bf16_f32 v101, v202, v203
    v_cvt_pk_bf16_f32 v102, v204, v205
    v_cvt_pk_bf16_f32 v103, v206, v207
    s_waitcnt vmcnt(0)
    ds_read_b128 v[244:247], v10 offset:1024
    s_waitcnt lgkmcnt(7)
    v_mfma_f32_32x32x16_bf16 v[128:143], v[176:179], v[80:83], v[128:143]
    ds_read_b128 v[192:195], v11 offset:1536
    ds_read_b128 v[248:251], v10 offset:5120
    s_waitcnt lgkmcnt(7)
    v_mfma_f32_32x32x16_bf16 v[144:159], v[180:183], v[80:83], v[144:159]
    ds_read_b128 v[196:199], v11 offset:1568
    ds_read_b128 v[176:179], v4 offset:55296
    s_waitcnt lgkmcnt(7)
    v_mfma_f32_32x32x16_bf16 v[160:175], v[80:83], v[184:187], v[160:175]
    s_waitcnt lgkmcnt(6)
    v_and_b32 v232, v243, v5
    v_and_b32 v233, v243, v6
    v_and_b32 v234, v243, v7
    v_and_b32 v235, v243, v8
    v_and_b32 v236, v243, v12
    v_and_b32 v237, v243, v13
    v_and_b32 v238, v243, v240
    v_and_b32 v239, v243, v241
    v_mfma_f32_32x32x16_bf16 v[208:223], v[232:235], v[104:107], v[208:223]
    s_nop 0
    v_mfma_f32_32x32x16_bf16 v[208:223], v[236:239], v[108:111], v[208:223]
    ds_read_b128 v[200:203], v11 offset:1600
    ds_read_b128 v[180:183], v10 offset:2048
    s_waitcnt lgkmcnt(7)
    v_mfma_f32_32x32x16_bf16 v[128:143], v[188:191], v[84:87], v[128:143]
    ds_read_b128 v[204:207], v11 offset:1632
    ds_read_b128 v[184:187], v10 offset:6144
    s_waitcnt lgkmcnt(8)
    v_mfma_f32_32x32x16_bf16 v[144:159], v[244:247], v[84:87], v[144:159]
    ds_read_b32 v242, v9 offset:3584
    ds_read_b128 v[188:191], v4 offset:56320
    s_waitcnt lgkmcnt(8)
    v_mfma_f32_32x32x16_bf16 v[160:175], v[84:87], v[248:251], v[160:175]
    v_cvt_pk_bf16_f32 v104, v208, v209
    v_cvt_pk_bf16_f32 v105, v210, v211
    v_cvt_pk_bf16_f32 v106, v212, v213
    v_cvt_pk_bf16_f32 v107, v214, v215
    v_cvt_pk_bf16_f32 v108, v216, v217
    v_cvt_pk_bf16_f32 v109, v218, v219
    v_cvt_pk_bf16_f32 v110, v220, v221
    v_cvt_pk_bf16_f32 v111, v222, v223
    ds_read_b128 v[244:247], v10 offset:3072
    s_waitcnt lgkmcnt(7)
    v_mfma_f32_32x32x16_bf16 v[128:143], v[176:179], v[88:91], v[128:143]
    ds_read_b128 v[208:211], v11 offset:1664
    ds_read_b128 v[248:251], v10 offset:7168
    s_waitcnt lgkmcnt(7)
    v_mfma_f32_32x32x16_bf16 v[144:159], v[180:183], v[88:91], v[144:159]
    ds_read_b128 v[212:215], v11 offset:1696
    s_barrier
    ds_read_b128 v[176:179], v10 offset:8192
    s_waitcnt lgkmcnt(7)
    v_mfma_f32_32x32x16_bf16 v[160:175], v[88:91], v[184:187], v[160:175]
    ds_read_b128 v[216:219], v11 offset:1728
    s_waitcnt lgkmcnt(7)
    v_and_b32 v224, v242, v5
    v_and_b32 v225, v242, v6
    v_and_b32 v226, v242, v7
    v_and_b32 v227, v242, v8
    v_and_b32 v228, v242, v12
    v_and_b32 v229, v242, v13
    v_and_b32 v230, v242, v240
    v_and_b32 v231, v242, v241
    v_mfma_f32_32x32x16_bf16 v[192:207], v[224:227], v[112:115], v[192:207]
    s_nop 0
    v_mfma_f32_32x32x16_bf16 v[192:207], v[228:231], v[116:119], v[192:207]
    ds_read_b128 v[180:183], v10 offset:12288
    s_waitcnt lgkmcnt(7)
    v_mfma_f32_32x32x16_bf16 v[128:143], v[188:191], v[92:95], v[128:143]
    ds_read_b128 v[220:223], v11 offset:1760
    ds_read_b128 v[184:187], v10 offset:16384
    s_waitcnt lgkmcnt(8)
    v_mfma_f32_32x32x16_bf16 v[144:159], v[244:247], v[92:95], v[144:159]
    ds_read_b32 v243, v9 offset:3712
    ds_read_b128 v[188:191], v10 offset:9216
    s_waitcnt lgkmcnt(8)
    v_mfma_f32_32x32x16_bf16 v[160:175], v[92:95], v[248:251], v[160:175]
    s_nop 0
    v_cvt_pk_bf16_f32 v112, v192, v193
    v_cvt_pk_bf16_f32 v113, v194, v195
    v_cvt_pk_bf16_f32 v114, v196, v197
    v_cvt_pk_bf16_f32 v115, v198, v199
    v_cvt_pk_bf16_f32 v116, v200, v201
    v_cvt_pk_bf16_f32 v117, v202, v203
    v_cvt_pk_bf16_f32 v118, v204, v205
    v_cvt_pk_bf16_f32 v119, v206, v207
    ds_read_b128 v[244:247], v10 offset:13312
    s_waitcnt lgkmcnt(7)
    v_mfma_f32_32x32x16_bf16 v[128:143], v[176:179], v[96:99], v[128:143]
    ds_read_b128 v[248:251], v10 offset:17408
    s_waitcnt lgkmcnt(6)
    v_mfma_f32_32x32x16_bf16 v[144:159], v[180:183], v[96:99], v[144:159]
    ds_read_b128 v[176:179], v10 offset:10240
    s_waitcnt lgkmcnt(5)
    v_mfma_f32_32x32x16_bf16 v[160:175], v[96:99], v[184:187], v[160:175]
    s_waitcnt lgkmcnt(4)
    v_and_b32 v232, v243, v5
    v_and_b32 v233, v243, v6
    v_and_b32 v234, v243, v7
    v_and_b32 v235, v243, v8
    v_and_b32 v236, v243, v12
    v_and_b32 v237, v243, v13
    v_and_b32 v238, v243, v240
    v_and_b32 v239, v243, v241
    v_mfma_f32_32x32x16_bf16 v[208:223], v[232:235], v[120:123], v[208:223]
    s_nop 0
    v_mfma_f32_32x32x16_bf16 v[208:223], v[236:239], v[124:127], v[208:223]
    ds_read_b128 v[180:183], v10 offset:14336
    s_waitcnt lgkmcnt(4)
    v_mfma_f32_32x32x16_bf16 v[128:143], v[188:191], v[100:103], v[128:143]
    ds_read_b128 v[184:187], v10 offset:18432
    s_waitcnt lgkmcnt(4)
    v_mfma_f32_32x32x16_bf16 v[144:159], v[244:247], v[100:103], v[144:159]
    ds_read_b128 v[188:191], v10 offset:11264
    s_waitcnt lgkmcnt(4)
    v_mfma_f32_32x32x16_bf16 v[160:175], v[100:103], v[248:251], v[160:175]
    s_nop 2
    v_cvt_pk_bf16_f32 v120, v208, v209
    v_cvt_pk_bf16_f32 v121, v210, v211
    v_cvt_pk_bf16_f32 v122, v212, v213
    v_cvt_pk_bf16_f32 v123, v214, v215
    v_cvt_pk_bf16_f32 v124, v216, v217
    v_cvt_pk_bf16_f32 v125, v218, v219
    v_cvt_pk_bf16_f32 v126, v220, v221
    v_cvt_pk_bf16_f32 v127, v222, v223
    ds_read_b128 v[244:247], v10 offset:15360
    s_waitcnt lgkmcnt(4)
    v_mfma_f32_32x32x16_bf16 v[128:143], v[176:179], v[104:107], v[128:143]
    ds_read_b128 v[248:251], v10 offset:19456
    s_waitcnt lgkmcnt(4)
    v_mfma_f32_32x32x16_bf16 v[144:159], v[180:183], v[104:107], v[144:159]
    ds_read_b128 v[176:179], v4 offset:4096
    s_waitcnt lgkmcnt(4)
    v_mfma_f32_32x32x16_bf16 v[160:175], v[104:107], v[184:187], v[160:175]
    ds_read_b128 v[180:183], v4 offset:8192
    s_waitcnt lgkmcnt(4)
    v_mfma_f32_32x32x16_bf16 v[128:143], v[188:191], v[108:111], v[128:143]
    ds_read_b128 v[184:187], v4 offset:12288
    s_waitcnt lgkmcnt(4)
    v_mfma_f32_32x32x16_bf16 v[144:159], v[244:247], v[108:111], v[144:159]
    ds_read_b128 v[188:191], v4 offset:5120
    s_waitcnt lgkmcnt(4)
    v_mfma_f32_32x32x16_bf16 v[160:175], v[108:111], v[248:251], v[160:175]
    ds_read_b128 v[244:247], v4 offset:9216
    s_waitcnt lgkmcnt(4)
    v_mfma_f32_32x32x16_bf16 v[128:143], v[176:179], v[112:115], v[128:143]
    ds_read_b128 v[248:251], v4 offset:13312
    s_waitcnt lgkmcnt(4)
    v_mfma_f32_32x32x16_bf16 v[144:159], v[180:183], v[112:115], v[144:159]
    ds_read_b128 v[176:179], v4 offset:6144
    s_waitcnt lgkmcnt(4)
    v_mfma_f32_32x32x16_bf16 v[160:175], v[112:115], v[184:187], v[160:175]
    ds_read_b128 v[180:183], v4 offset:10240
    s_waitcnt lgkmcnt(4)
    v_mfma_f32_32x32x16_bf16 v[128:143], v[188:191], v[116:119], v[128:143]
    ds_read_b128 v[184:187], v4 offset:14336
    s_waitcnt lgkmcnt(4)
    v_mfma_f32_32x32x16_bf16 v[144:159], v[244:247], v[116:119], v[144:159]
    ds_read_b128 v[188:191], v4 offset:7168
    s_waitcnt lgkmcnt(4)
    v_mfma_f32_32x32x16_bf16 v[160:175], v[116:119], v[248:251], v[160:175]
    ds_read_b128 v[244:247], v4 offset:11264
    s_waitcnt lgkmcnt(4)
    v_mfma_f32_32x32x16_bf16 v[128:143], v[176:179], v[120:123], v[128:143]
    ds_read_b128 v[248:251], v4 offset:15360
    s_waitcnt lgkmcnt(4)
    v_mfma_f32_32x32x16_bf16 v[144:159], v[180:183], v[120:123], v[144:159]
    s_waitcnt lgkmcnt(3)
    v_mfma_f32_32x32x16_bf16 v[160:175], v[120:123], v[184:187], v[160:175]
    s_waitcnt lgkmcnt(2)
    v_mfma_f32_32x32x16_bf16 v[128:143], v[188:191], v[124:127], v[128:143]
    s_waitcnt lgkmcnt(1)
    v_mfma_f32_32x32x16_bf16 v[144:159], v[244:247], v[124:127], v[144:159]
    s_waitcnt lgkmcnt(0)
    v_mfma_f32_32x32x16_bf16 v[160:175], v[124:127], v[248:251], v[160:175]
    s_nop 7
    v_mul_f32 v128, s14, v128
    v_mul_f32 v129, s14, v129
    v_mul_f32 v130, s14, v130
    v_mul_f32 v131, s14, v131
    v_mul_f32 v132, s14, v132
    v_mul_f32 v133, s14, v133
    v_mul_f32 v134, s14, v134
    v_mul_f32 v135, s14, v135
    v_mul_f32 v136, s14, v136
    v_mul_f32 v137, s14, v137
    v_mul_f32 v138, s14, v138
    v_mul_f32 v139, s14, v139
    v_mul_f32 v140, s14, v140
    v_mul_f32 v141, s14, v141
    v_mul_f32 v142, s14, v142
    v_mul_f32 v143, s14, v143
    v_cvt_pk_bf16_f32 v128, v128, v129
    v_cvt_pk_bf16_f32 v129, v130, v131
    v_cvt_pk_bf16_f32 v130, v132, v133
    v_cvt_pk_bf16_f32 v131, v134, v135
    v_cvt_pk_bf16_f32 v132, v136, v137
    v_cvt_pk_bf16_f32 v133, v138, v139
    v_cvt_pk_bf16_f32 v134, v140, v141
    v_cvt_pk_bf16_f32 v135, v142, v143
    buffer_store_dwordx4 v[128:131], v4, s[36:39], s13 offen sc1
    buffer_store_dwordx4 v[132:135], v4, s[36:39], s13 offen offset:1024 sc1
    s_add_u32 s13, s13, 0x200000
    v_cndmask_b32 v156, v156, 1.0, s[44:45]
    v_cndmask_b32 v157, v157, 1.0, s[44:45]
    v_cvt_pk_bf16_f32 v144, v144, v145
    v_cvt_pk_bf16_f32 v145, v146, v147
    v_cvt_pk_bf16_f32 v146, v148, v149
    v_cvt_pk_bf16_f32 v147, v150, v151
    v_cvt_pk_bf16_f32 v148, v152, v153
    v_cvt_pk_bf16_f32 v149, v154, v155
    v_cvt_pk_bf16_f32 v150, v156, v157
    v_cvt_pk_bf16_f32 v151, v158, v159
    buffer_store_dwordx4 v[144:147], v4, s[36:39], s13 offen sc1
    buffer_store_dwordx4 v[148:151], v4, s[36:39], s13 offen offset:1024 sc1
    s_add_u32 s13, s13, 0x200000
    v_cndmask_b32 v160, v160, 1.0, s[46:47]
    v_cndmask_b32 v161, v161, 1.0, s[46:47]
    v_cndmask_b32 v162, v162, 1.0, s[46:47]
    v_cndmask_b32 v163, v163, 1.0, s[46:47]
    v_cndmask_b32 v164, v164, 1.0, s[46:47]
    v_cndmask_b32 v165, v165, 1.0, s[46:47]
    v_cndmask_b32 v166, v166, 1.0, s[46:47]
    v_cndmask_b32 v167, v167, 1.0, s[46:47]
    v_cndmask_b32 v168, v168, 1.0, s[46:47]
    v_cndmask_b32 v169, v169, 1.0, s[46:47]
    v_cndmask_b32 v170, v170, 1.0, s[46:47]
    v_cndmask_b32 v171, v171, 1.0, s[46:47]
    v_cndmask_b32 v172, v172, 1.0, s[46:47]
    v_cndmask_b32 v173, v173, 1.0, s[46:47]
    v_cndmask_b32 v174, v174, 1.0, s[46:47]
    v_cndmask_b32 v175, v175, 1.0, s[46:47]
    v_cvt_pk_bf16_f32 v160, v160, v161
    v_cvt_pk_bf16_f32 v161, v162, v163
    v_cvt_pk_bf16_f32 v162, v164, v165
    v_cvt_pk_bf16_f32 v163, v166, v167
    v_cvt_pk_bf16_f32 v164, v168, v169
    v_cvt_pk_bf16_f32 v165, v170, v171
    v_cvt_pk_bf16_f32 v166, v172, v173
    v_cvt_pk_bf16_f32 v167, v174, v175
    buffer_store_dwordx4 v[160:163], v4, s[36:39], s13 offen sc1
    buffer_store_dwordx4 v[164:167], v4, s[36:39], s13 offen offset:1024 sc1
K2_END:
    s_endpgm
.globl attn_kernel
.p2align 8
.type attn_kernel,@function
attn_kernel:
    s_cmp_ge_u32 s2, 256
    s_cbranch_scc1 K3_END
    s_load_dwordx2 s[34:35], s[0:1], 80
    s_load_dwordx2 s[16:17], s[0:1], 0
    s_load_dwordx2 s[24:25], s[0:1], 32
    s_waitcnt lgkmcnt(0)
    s_mov_b32 s36, s34
    s_mov_b32 s37, s35
    s_mov_b32 s38, 0x1b00000
    s_mov_b32 s39, 0x00020000
    s_mov_b32 s40, s16
    s_mov_b32 s41, s17
    s_mov_b32 s42, 0x1c0000
    s_mov_b32 s43, 0x00020000
    v_lshrrev_b32 v8, 6, v0
    s_nop 0
    v_readfirstlane_b32 s6, v8
    v_and_b32 v1, 63, v0
    v_and_b32 v2, 31, v0
    v_bfe_u32 v3, v0, 5, 1
    v_lshlrev_b32 v4, 4, v1
    s_and_b32 s4, s2, 15
    s_lshr_b32 s3, s2, 4
    s_lshl_b32 s7, s4, 6
    s_lshl_b32 s8, s3, 2
    s_add_u32 s7, s7, s8
    s_lshl_b32 s7, s7, 11
    s_add_u32 s7, s7, 0x700000
    s_lshl_b32 s9, s4, 6
    s_lshl_b32 s10, s6, 3
    s_add_u32 s9, s9, s10
    s_lshl_b32 s9, s9, 11
    s_add_u32 s9, s9, 0x900000
    s_add_u32 s10, s9, 0x200000
    s_lshl_b32 s8, s6, 10
    s_add_u32 s7, s7, s8
    s_add_u32 s8, s8, 4096
    s_mov_b32 m0, s8
    s_nop 0
    buffer_load_dwordx4 v4, s[36:39], s7 offen lds
    buffer_load_dwordx4 v[160:163], v4, s[36:39], s9 offen
    buffer_load_dwordx4 v[164:167], v4, s[36:39], s9 offen offset:1024
    buffer_load_dwordx4 v[192:195], v4, s[36:39], s10 offen
    buffer_load_dwordx4 v[196:199], v4, s[36:39], s10 offen offset:1024
    s_add_u32 s9, s9, 2048
    s_add_u32 s10, s10, 2048
    buffer_load_dwordx4 v[168:171], v4, s[36:39], s9 offen
    buffer_load_dwordx4 v[172:175], v4, s[36:39], s9 offen offset:1024
    buffer_load_dwordx4 v[200:203], v4, s[36:39], s10 offen
    buffer_load_dwordx4 v[204:207], v4, s[36:39], s10 offen offset:1024
    s_add_u32 s9, s9, 2048
    s_add_u32 s10, s10, 2048
    buffer_load_dwordx4 v[176:179], v4, s[36:39], s9 offen
    buffer_load_dwordx4 v[180:183], v4, s[36:39], s9 offen offset:1024
    buffer_load_dwordx4 v[208:211], v4, s[36:39], s10 offen
    buffer_load_dwordx4 v[212:215], v4, s[36:39], s10 offen offset:1024
    s_add_u32 s9, s9, 2048
    s_add_u32 s10, s10, 2048
    v_mov_b32 v48, 0
    v_mov_b32 v49, 0
    v_mov_b32 v50, 0
    v_mov_b32 v51, 0
    v_mov_b32 v52, 0
    v_mov_b32 v53, 0
    v_mov_b32 v54, 0
    v_mov_b32 v55, 0
    v_mov_b32 v56, 0
    v_mov_b32 v57, 0
    v_mov_b32 v58, 0
    v_mov_b32 v59, 0
    v_mov_b32 v60, 0
    v_mov_b32 v61, 0
    v_mov_b32 v62, 0
    v_mov_b32 v63, 0
    v_mov_b32 v64, 0
    v_mov_b32 v65, 0
    v_mov_b32 v66, 0
    v_mov_b32 v67, 0
    v_mov_b32 v68, 0
    v_mov_b32 v69, 0
    v_mov_b32 v70, 0
    v_mov_b32 v71, 0
    v_mov_b32 v72, 0
    v_mov_b32 v73, 0
    v_mov_b32 v74, 0
    v_mov_b32 v75, 0
    v_mov_b32 v76, 0
    v_mov_b32 v77, 0
    v_mov_b32 v78, 0
    v_mov_b32 v79, 0
    v_mov_b32 v80, 0
    v_mov_b32 v81, 0
    v_mov_b32 v82, 0
    v_mov_b32 v83, 0
    v_mov_b32 v84, 0
    v_mov_b32 v85, 0
    v_mov_b32 v86, 0
    v_mov_b32 v87, 0
    v_mov_b32 v88, 0
    v_mov_b32 v89, 0
    v_mov_b32 v90, 0
    v_mov_b32 v91, 0
    v_mov_b32 v92, 0
    v_mov_b32 v93, 0
    v_mov_b32 v94, 0
    v_mov_b32 v95, 0
    v_mov_b32 v96, 0
    v_mov_b32 v97, 0
    v_mov_b32 v98, 0
    v_mov_b32 v99, 0
    v_mov_b32 v100, 0
    v_mov_b32 v101, 0
    v_mov_b32 v102, 0
    v_mov_b32 v103, 0
    v_mov_b32 v104, 0
    v_mov_b32 v105, 0
    v_mov_b32 v106, 0
    v_mov_b32 v107, 0
    v_mov_b32 v108, 0
    v_mov_b32 v109, 0
    v_mov_b32 v110, 0
    v_mov_b32 v111, 0
    v_mov_b32 v152, 0
    v_mov_b32 v216, 0
    v_mov_b32 v153, 0
    v_mov_b32 v217, 0
    v_mov_b32 v154, 0
    v_mov_b32 v218, 0
    v_mov_b32 v155, 0
    v_mov_b32 v219, 0
    v_mov_b32 v156, 0
    v_mov_b32 v220, 0
    v_mov_b32 v157, 0
    v_mov_b32 v221, 0
    v_mov_b32 v158, 0
    v_mov_b32 v222, 0
    v_mov_b32 v159, 0
    v_mov_b32 v223, 0
    v_mov_b32 v224, 0
    v_mov_b32 v225, 0
    v_mov_b32 v226, 0
    v_mov_b32 v227, 0
    v_cmp_eq_u32 s[44:45], 1, v3
    s_mov_b32 s51, 1
    s_mov_b64 vcc, 0
    s_mov_b32 s48, 0
    s_mov_b32 s49, 0x40e00000
    s_mov_b32 s50, 0x40004000
    s_mov_b32 s11, 0
    s_waitcnt vmcnt(12)
    s_barrier
    ds_read_b128 v[16:19], v4 offset:4096
    ds_read_b128 v[20:23], v4 offset:5120
    ds_read_b128 v[24:27], v4 offset:6144
    ds_read_b128 v[28:31], v4 offset:7168
    ds_read_b128 v[32:35], v4 offset:8192
    ds_read_b128 v[36:39], v4 offset:9216
    ds_read_b128 v[40:43], v4 offset:10240
    ds_read_b128 v[44:47], v4 offset:11264
    s_waitcnt vmcnt(8) lgkmcnt(0)
    v_mfma_f32_32x32x16_bf16 v[112:127], v[160:163], v[16:19], 0
    v_mfma_f32_32x32x16_bf16 v[112:127], v[164:167], v[20:23], v[112:127]
    v_mfma_f32_32x32x16_bf16 v[128:143], v[160:163], v[24:27], 0
    v_mfma_f32_32x32x16_bf16 v[128:143], v[164:167], v[28:31], v[128:143]
    s_nop 9
    v_max3_f32 v228, v112, v113, v114
    v_max3_f32 v228, v228, v115, v116
    v_max3_f32 v228, v228, v117, v118
    v_max3_f32 v228, v228, v119, v120
    v_max3_f32 v228, v228, v121, v122
    v_max3_f32 v228, v228, v123, v124
    v_max3_f32 v228, v228, v125, v126
    v_max_f32 v228, v228, v127
    v_mov_b32 v229, v228
    s_nop 1
    v_permlane32_swap_b32 v228, v229
    v_max_f32 v228, v228, v229
    v_add_f32 v228, s49, v228
    v_cvt_pk_bf16_f32 v229, v228, v228
    v_lshlrev_b32 v229, 16, v229
    v_sub_f32 v230, v228, v229
    v_cvt_pk_bf16_f32 v231, v229, v230
    v_and_b32 v230, 0xffff0000, v231
    v_add_f32 v224, v229, v230
    v_xor_b32 v231, 0x80008000, v231
    v_cndmask_b32 v22, v22, v231, s[44:45]
    v_mfma_f32_32x32x16_bf16 v[232:247], v[160:163], v[32:35], 0
    v_mfma_f32_32x32x16_bf16 v[232:247], v[164:167], v[36:39], v[232:247]
    v_max3_f32 v228, v128, v129, v130
    v_max3_f32 v228, v228, v131, v132
    v_max3_f32 v228, v228, v133, v134
    v_max3_f32 v228, v228, v135, v136
    v_max3_f32 v228, v228, v137, v138
    v_max3_f32 v228, v228, v139, v140
    v_max3_f32 v228, v228, v141, v142
    v_max_f32 v228, v228, v143
    v_mov_b32 v229, v228
    s_nop 1
    v_permlane32_swap_b32 v228, v229
    v_max_f32 v228, v228, v229
    v_add_f32 v228, s49, v228
    v_cvt_pk_bf16_f32 v229, v228, v228
    v_lshlrev_b32 v229, 16, v229
    v_sub_f32 v230, v228, v229
    v_cvt_pk_bf16_f32 v231, v229, v230
    v_and_b32 v230, 0xffff0000, v231
    v_add_f32 v225, v229, v230
    v_xor_b32 v231, 0x80008000, v231
    v_cndmask_b32 v30, v30, v231, s[44:45]
    v_mfma_f32_32x32x16_bf16 v[112:127], v[160:163], v[40:43], 0
    v_mfma_f32_32x32x16_bf16 v[112:127], v[164:167], v[44:47], v[112:127]
    v_max3_f32 v228, v232, v233, v234
    v_max3_f32 v228, v228, v235, v236
    v_max3_f32 v228, v228, v237, v238
    v_max3_f32 v228, v228, v239, v240
    v_max3_f32 v228, v228, v241, v242
    v_max3_f32 v228, v228, v243, v244
    v_max3_f32 v228, v228, v245, v246
    v_max_f32 v228, v228, v247
    v_mov_b32 v229, v228
    s_nop 1
    v_permlane32_swap_b32 v228, v229
    v_max_f32 v228, v228, v229
    v_add_f32 v228, s49, v228
    v_cvt_pk_bf16_f32 v229, v228, v228
    v_lshlrev_b32 v229, 16, v229
    v_sub_f32 v230, v228, v229
    v_cvt_pk_bf16_f32 v231, v229, v230
    v_and_b32 v230, 0xffff0000, v231
    v_add_f32 v226, v229, v230
    v_xor_b32 v231, 0x80008000, v231
    v_cndmask_b32 v38, v38, v231, s[44:45]
    v_max3_f32 v228, v112, v113, v114
    v_max3_f32 v228, v228, v115, v116
    v_max3_f32 v228, v228, v117, v118
    v_max3_f32 v228, v228, v119, v120
    v_max3_f32 v228, v228, v121, v122
    v_max3_f32 v228, v228, v123, v124
    v_max3_f32 v228, v228, v125, v126
    v_max_f32 v228, v228, v127
    v_mov_b32 v229, v228
    s_nop 1
    v_permlane32_swap_b32 v228, v229
    v_max_f32 v228, v228, v229
    v_add_f32 v228, s49, v228
    v_cvt_pk_bf16_f32 v229, v228, v228
    v_lshlrev_b32 v229, 16, v229
    v_sub_f32 v230, v228, v229
    v_cvt_pk_bf16_f32 v231, v229, v230
    v_and_b32 v230, 0xffff0000, v231
    v_add_f32 v227, v229, v230
    v_xor_b32 v231, 0x80008000, v231
    v_cndmask_b32 v46, v46, v231, s[44:45]
    s_nop 1
    v_mfma_f32_32x32x16_bf16 v[112:127], v[160:163], v[16:19], 0
    v_mfma_f32_32x32x16_bf16 v[112:127], v[164:167], v[20:23], v[112:127]
K3_LOOP:
    s_nop 11
    v_exp_f32 v112, v112
    v_exp_f32 v113, v113
    v_exp_f32 v114, v114
    v_exp_f32 v115, v115
    v_mfma_f32_32x32x16_bf16 v[128:143], v[160:163], v[24:27], 0
    v_exp_f32 v116, v116
    v_exp_f32 v117, v117
    v_exp_f32 v118, v118
    v_exp_f32 v119, v119
    v_mfma_f32_32x32x16_bf16 v[128:143], v[164:167], v[28:31], v[128:143]
    v_exp_f32 v120, v120
    v_exp_f32 v121, v121
    v_exp_f32 v122, v122
    v_exp_f32 v123, v123
    s_cbranch_vccnz K3_RARE15
K3_BACK15:
    v_mfma_f32_32x32x16_bf16 v[96:111], v[216:219], v[152:155], v[96:111]
    v_exp_f32 v124, v124
    v_exp_f32 v125, v125
    v_exp_f32 v126, v126
    v_exp_f32 v127, v127
    v_mfma_f32_32x32x16_bf16 v[96:111], v[220:223], v[156:159], v[96:111]
    v_cvt_pk_bf16_f32 v144, v112, v113
    v_cvt_pk_bf16_f32 v145, v114, v115
    v_cvt_pk_bf16_f32 v146, v116, v117
    v_cvt_pk_bf16_f32 v147, v118, v119
    v_cvt_pk_bf16_f32 v148, v120, v121
    v_cvt_pk_bf16_f32 v149, v122, v123
    v_cvt_pk_bf16_f32 v150, v124, v125
    v_cvt_pk_bf16_f32 v151, v126, v127
    v_or3_b32 v228, v144, v145, v146
    v_or3_b32 v229, v147, v148, v149
    v_or3_b32 v228, v228, v150, v151
    v_or_b32 v228, v228, v229
    v_and_b32 v228, s50, v228
    v_cmp_le_u32 vcc, s51, v228
    buffer_load_dwordx4 v[184:187], v4, s[36:39], s9 offen
    buffer_load_dwordx4 v[188:191], v4, s[36:39], s9 offen offset:1024
    buffer_load_dwordx4 v[216:219], v4, s[36:39], s10 offen
    buffer_load_dwordx4 v[220:223], v4, s[36:39], s10 offen offset:1024
    s_add_u32 s9, s9, 2048
    s_add_u32 s10, s10, 2048
    v_exp_f32 v128, v128
    v_exp_f32 v129, v129
    v_exp_f32 v130, v130
    v_exp_f32 v131, v131
    v_mfma_f32_32x32x16_bf16 v[112:127], v[160:163], v[32:35], 0
    v_exp_f32 v132, v132
    v_exp_f32 v133, v133
    v_exp_f32 v134, v134
    v_exp_f32 v135, v135
    v_mfma_f32_32x32x16_bf16 v[112:127], v[164:167], v[36:39], v[112:127]
    v_exp_f32 v136, v136
    v_exp_f32 v137, v137
    v_exp_f32 v138, v138
    v_exp_f32 v139, v139
    s_cbranch_vccnz K3_RARE0
K3_BACK0:
    v_mfma_f32_32x32x16_bf16 v[48:63], v[192:195], v[144:147], v[48:63]
    v_exp_f32 v140, v140
    v_exp_f32 v141, v141
    v_exp_f32 v142, v142
    v_exp_f32 v143, v143
    v_mfma_f32_32x32x16_bf16 v[48:63], v[196:199], v[148:151], v[48:63]
    v_cvt_pk_bf16_f32 v152, v128, v129
    v_cvt_pk_bf16_f32 v153, v130, v131
    v_cvt_pk_bf16_f32 v154, v132, v133
    v_cvt_pk_bf16_f32 v155, v134, v135
    v_cvt_pk_bf16_f32 v156, v136, v137
    v_cvt_pk_bf16_f32 v157, v138, v139
    v_cvt_pk_bf16_f32 v158, v140, v141
    v_cvt_pk_bf16_f32 v159, v142, v143
    v_or3_b32 v228, v152, v153, v154
    v_or3_b32 v229, v155, v156, v157
    v_or3_b32 v228, v228, v158, v159
    v_or_b32 v228, v228, v229
    v_and_b32 v228, s50, v228
    v_cmp_le_u32 vcc, s51, v228
    v_exp_f32 v112, v112
    v_exp_f32 v113, v113
    v_exp_f32 v114, v114
    v_exp_f32 v115, v115
    v_mfma_f32_32x32x16_bf16 v[128:143], v[160:163], v[40:43], 0
    v_exp_f32 v116, v116
    v_exp_f32 v117, v117
    v_exp_f32 v118, v118
    v_exp_f32 v119, v119
    v_mfma_f32_32x32x16_bf16 v[128:143], v[164:167], v[44:47], v[128:143]
    v_exp_f32 v120, v120
    v_exp_f32 v121, v121
    v_exp_f32 v122, v122
    v_exp_f32 v123, v123
    s_cbranch_vccnz K3_RARE1
K3_BACK1:
    v_mfma_f32_32x32x16_bf16 v[64:79], v[192:195], v[152:155], v[64:79]
    v_exp_f32 v124, v124
    v_exp_f32 v125, v125
    v_exp_f32 v126, v126
    v_exp_f32 v127, v127
    v_mfma_f32_32x32x16_bf16 v[64:79], v[196:199], v[156:159], v[64:79]
    v_cvt_pk_bf16_f32 v144, v112, v113
    v_cvt_pk_bf16_f32 v145, v114, v115
    v_cvt_pk_bf16_f32 v146, v116, v117
    v_cvt_pk_bf16_f32 v147, v118, v119
    v_cvt_pk_bf16_f32 v148, v120, v121
    v_cvt_pk_bf16_f32 v149, v122, v123
    v_cvt_pk_bf16_f32 v150, v124, v125
    v_cvt_pk_bf16_f32 v151, v126, v127
    v_or3_b32 v228, v144, v145, v146
    v_or3_b32 v229, v147, v148, v149
    v_or3_b32 v228, v228, v150, v151
    v_or_b32 v228, v228, v229
    v_and_b32 v228, s50, v228
    v_cmp_le_u32 vcc, s51, v228
    s_waitcnt vmcnt(8)
    v_exp_f32 v128, v128
    v_exp_f32 v129, v129
    v_exp_f32 v130, v130
    v_exp_f32 v131, v131
    v_mfma_f32_32x32x16_bf16 v[112:127], v[168:171], v[16:19], 0
    v_exp_f32 v132, v132
    v_exp_f32 v133, v133
    v_exp_f32 v134, v134
    v_exp_f32 v135, v135
    v_mfma_f32_32x32x16_bf16 v[112:127], v[172:175], v[20:23], v[112:127]
    v_exp_f32 v136, v136
    v_exp_f32 v137, v137
    v_exp_f32 v138, v138
    v_exp_f32 v139, v139
    s_cbranch_vccnz K3_RARE2
K3_BACK2:
    v_mfma_f32_32x32x16_bf16 v[80:95], v[192:195], v[144:147], v[80:95]
    v_exp_f32 v140, v140
    v_exp_f32 v141, v141
    v_exp_f32 v142, v142
    v_exp_f32 v143, v143
    v_mfma_f32_32x32x16_bf16 v[80:95], v[196:199], v[148:151], v[80:95]
    v_cvt_pk_bf16_f32 v152, v128, v129
    v_cvt_pk_bf16_f32 v153, v130, v131
    v_cvt_pk_bf16_f32 v154, v132, v133
    v_cvt_pk_bf16_f32 v155, v134, v135
    v_cvt_pk_bf16_f32 v156, v136, v137
    v_cvt_pk_bf16_f32 v157, v138, v139
    v_cvt_pk_bf16_f32 v158, v140, v141
    v_cvt_pk_bf16_f32 v159, v142, v143
    v_or3_b32 v228, v152, v153, v154
    v_or3_b32 v229, v155, v156, v157
    v_or3_b32 v228, v228, v158, v159
    v_or_b32 v228, v228, v229
    v_and_b32 v228, s50, v228
    v_cmp_le_u32 vcc, s51, v228
    v_exp_f32 v112, v112
    v_exp_f32 v113, v113
    v_exp_f32 v114, v114
    v_exp_f32 v115, v115
    v_mfma_f32_32x32x16_bf16 v[128:143], v[168:171], v[24:27], 0
    v_exp_f32 v116, v116
    v_exp_f32 v117, v117
    v_exp_f32 v118, v118
    v_exp_f32 v119, v119
    v_mfma_f32_32x32x16_bf16 v[128:143], v[172:175], v[28:31], v[128:143]
    v_exp_f32 v120, v120
    v_exp_f32 v121, v121
    v_exp_f32 v122, v122
    v_exp_f32 v123, v123
    s_cbranch_vccnz K3_RARE3
K3_BACK3:
    v_mfma_f32_32x32x16_bf16 v[96:111], v[192:195], v[152:155], v[96:111]
    v_exp_f32 v124, v124
    v_exp_f32 v125, v125
    v_exp_f32 v126, v126
    v_exp_f32 v127, v127
    v_mfma_f32_32x32x16_bf16 v[96:111], v[196:199], v[156:159], v[96:111]
    v_cvt_pk_bf16_f32 v144, v112, v113
    v_cvt_pk_bf16_f32 v145, v114, v115
    v_cvt_pk_bf16_f32 v146, v116, v117
    v_cvt_pk_bf16_f32 v147, v118, v119
    v_cvt_pk_bf16_f32 v148, v120, v121
    v_cvt_pk_bf16_f32 v149, v122, v123
    v_cvt_pk_bf16_f32 v150, v124, v125
    v_cvt_pk_bf16_f32 v151, v126, v127
    v_or3_b32 v228, v144, v145, v146
    v_or3_b32 v229, v147, v148, v149
    v_or3_b32 v228, v228, v150, v151
    v_or_b32 v228, v228, v229
    v_and_b32 v228, s50, v228
    v_cmp_le_u32 vcc, s51, v228
    buffer_load_dwordx4 v[160:163], v4, s[36:39], s9 offen
    buffer_load_dwordx4 v[164:167], v4, s[36:39], s9 offen offset:1024
    buffer_load_dwordx4 v[192:195], v4, s[36:39], s10 offen
    buffer_load_dwordx4 v[196:199], v4, s[36:39], s10 offen offset:1024
    s_add_u32 s9, s9, 2048
    s_add_u32 s10, s10, 2048
    v_exp_f32 v128, v128
    v_exp_f32 v129, v129
    v_exp_f32 v130, v130
    v_exp_f32 v131, v131
    v_mfma_f32_32x32x16_bf16 v[112:127], v[168:171], v[32:35], 0
    v_exp_f32 v132, v132
    v_exp_f32 v133, v133
    v_exp_f32 v134, v134
    v_exp_f32 v135, v135
    v_mfma_f32_32x32x16_bf16 v[112:127], v[172:175], v[36:39], v[112:127]
    v_exp_f32 v136, v136
    v_exp_f32 v137, v137
    v_exp_f32 v138, v138
    v_exp_f32 v139, v139
    s_cbranch_vccnz K3_RARE4
K3_BACK4:
    v_mfma_f32_32x32x16_bf16 v[48:63], v[200:203], v[144:147], v[48:63]
    v_exp_f32 v140, v140
    v_exp_f32 v141, v141
    v_exp_f32 v142, v142
    v_exp_f32 v143, v143
    v_mfma_f32_32x32x16_bf16 v[48:63], v[204:207], v[148:151], v[48:63]
    v_cvt_pk_bf16_f32 v152, v128, v129
    v_cvt_pk_bf16_f32 v153, v130, v131
    v_cvt_pk_bf16_f32 v154, v132, v133
    v_cvt_pk_bf16_f32 v155, v134, v135
    v_cvt_pk_bf16_f32 v156, v136, v137
    v_cvt_pk_bf16_f32 v157, v138, v139
    v_cvt_pk_bf16_f32 v158, v140, v141
    v_cvt_pk_bf16_f32 v159, v142, v143
    v_or3_b32 v228, v152, v153, v154
    v_or3_b32 v229, v155, v156, v157
    v_or3_b32 v228, v228, v158, v159
    v_or_b32 v228, v228, v229
    v_and_b32 v228, s50, v228
    v_cmp_le_u32 vcc, s51, v228
    v_exp_f32 v112, v112
    v_exp_f32 v113, v113
    v_exp_f32 v114, v114
    v_exp_f32 v115, v115
    v_mfma_f32_32x32x16_bf16 v[128:143], v[168:171], v[40:43], 0
    v_exp_f32 v116, v116
    v_exp_f32 v117, v117
    v_exp_f32 v118, v118
    v_exp_f32 v119, v119
    v_mfma_f32_32x32x16_bf16 v[128:143], v[172:175], v[44:47], v[128:143]
    v_exp_f32 v120, v120
    v_exp_f32 v121, v121
    v_exp_f32 v122, v122
    v_exp_f32 v123, v123
    s_cbranch_vccnz K3_RARE5
K3_BACK5:
    v_mfma_f32_32x32x16_bf16 v[64:79], v[200:203], v[152:155], v[64:79]
    v_exp_f32 v124, v124
    v_exp_f32 v125, v125
    v_exp_f32 v126, v126
    v_exp_f32 v127, v127
    v_mfma_f32_32x32x16_bf16 v[64:79], v[204:207], v[156:159], v[64:79]
    v_cvt_pk_bf16_f32 v144, v112, v113
    v_cvt_pk_bf16_f32 v145, v114, v115
    v_cvt_pk_bf16_f32 v146, v116, v117
    v_cvt_pk_bf16_f32 v147, v118, v119
    v_cvt_pk_bf16_f32 v148, v120, v121
    v_cvt_pk_bf16_f32 v149, v122, v123
    v_cvt_pk_bf16_f32 v150, v124, v125
    v_cvt_pk_bf16_f32 v151, v126, v127
    v_or3_b32 v228, v144, v145, v146
    v_or3_b32 v229, v147, v148, v149
    v_or3_b32 v228, v228, v150, v151
    v_or_b32 v228, v228, v229
    v_and_b32 v228, s50, v228
    v_cmp_le_u32 vcc, s51, v228
    s_waitcnt vmcnt(8)
    v_exp_f32 v128, v128
    v_exp_f32 v129, v129
    v_exp_f32 v130, v130
    v_exp_f32 v131, v131
    v_mfma_f32_32x32x16_bf16 v[112:127], v[176:179], v[16:19], 0
    v_exp_f32 v132, v132
    v_exp_f32 v133, v133
    v_exp_f32 v134, v134
    v_exp_f32 v135, v135
    v_mfma_f32_32x32x16_bf16 v[112:127], v[180:183], v[20:23], v[112:127]
    v_exp_f32 v136, v136
    v_exp_f32 v137, v137
    v_exp_f32 v138, v138
    v_exp_f32 v139, v139
    s_cbranch_vccnz K3_RARE6
K3_BACK6:
    v_mfma_f32_32x32x16_bf16 v[80:95], v[200:203], v[144:147], v[80:95]
    v_exp_f32 v140, v140
    v_exp_f32 v141, v141
    v_exp_f32 v142, v142
    v_exp_f32 v143, v143
    v_mfma_f32_32x32x16_bf16 v[80:95], v[204:207], v[148:151], v[80:95]
    v_cvt_pk_bf16_f32 v152, v128, v129
    v_cvt_pk_bf16_f32 v153, v130, v131
    v_cvt_pk_bf16_f32 v154, v132, v133
    v_cvt_pk_bf16_f32 v155, v134, v135
    v_cvt_pk_bf16_f32 v156, v136, v137
    v_cvt_pk_bf16_f32 v157, v138, v139
    v_cvt_pk_bf16_f32 v158, v140, v141
    v_cvt_pk_bf16_f32 v159, v142, v143
    v_or3_b32 v228, v152, v153, v154
    v_or3_b32 v229, v155, v156, v157
    v_or3_b32 v228, v228, v158, v159
    v_or_b32 v228, v228, v229
    v_and_b32 v228, s50, v228
    v_cmp_le_u32 vcc, s51, v228
    v_exp_f32 v112, v112
    v_exp_f32 v113, v113
    v_exp_f32 v114, v114
    v_exp_f32 v115, v115
    v_mfma_f32_32x32x16_bf16 v[128:143], v[176:179], v[24:27], 0
    v_exp_f32 v116, v116
    v_exp_f32 v117, v117
    v_exp_f32 v118, v118
    v_exp_f32 v119, v119
    v_mfma_f32_32x32x16_bf16 v[128:143], v[180:183], v[28:31], v[128:143]
    v_exp_f32 v120, v120
    v_exp_f32 v121, v121
    v_exp_f32 v122, v122
    v_exp_f32 v123, v123
    s_cbranch_vccnz K3_RARE7
K3_BACK7:
    v_mfma_f32_32x32x16_bf16 v[96:111], v[200:203], v[152:155], v[96:111]
    v_exp_f32 v124, v124
    v_exp_f32 v125, v125
    v_exp_f32 v126, v126
    v_exp_f32 v127, v127
    v_mfma_f32_32x32x16_bf16 v[96:111], v[204:207], v[156:159], v[96:111]
    v_cvt_pk_bf16_f32 v144, v112, v113
    v_cvt_pk_bf16_f32 v145, v114, v115
    v_cvt_pk_bf16_f32 v146, v116, v117
    v_cvt_pk_bf16_f32 v147, v118, v119
    v_cvt_pk_bf16_f32 v148, v120, v121
    v_cvt_pk_bf16_f32 v149, v122, v123
    v_cvt_pk_bf16_f32 v150, v124, v125
    v_cvt_pk_bf16_f32 v151, v126, v127
    v_or3_b32 v228, v144, v145, v146
    v_or3_b32 v229, v147, v148, v149
    v_or3_b32 v228, v228, v150, v151
    v_or_b32 v228, v228, v229
    v_and_b32 v228, s50, v228
    v_cmp_le_u32 vcc, s51, v228
    buffer_load_dwordx4 v[168:171], v4, s[36:39], s9 offen
    buffer_load_dwordx4 v[172:175], v4, s[36:39], s9 offen offset:1024
    buffer_load_dwordx4 v[200:203], v4, s[36:39], s10 offen
    buffer_load_dwordx4 v[204:207], v4, s[36:39], s10 offen offset:1024
    s_add_u32 s9, s9, 2048
    s_add_u32 s10, s10, 2048
    v_exp_f32 v128, v128
    v_exp_f32 v129, v129
    v_exp_f32 v130, v130
    v_exp_f32 v131, v131
    v_mfma_f32_32x32x16_bf16 v[112:127], v[176:179], v[32:35], 0
    v_exp_f32 v132, v132
    v_exp_f32 v133, v133
    v_exp_f32 v134, v134
    v_exp_f32 v135, v135
    v_mfma_f32_32x32x16_bf16 v[112:127], v[180:183], v[36:39], v[112:127]
    v_exp_f32 v136, v136
    v_exp_f32 v137, v137
    v_exp_f32 v138, v138
    v_exp_f32 v139, v139
    s_cbranch_vccnz K3_RARE8
K3_BACK8:
    v_mfma_f32_32x32x16_bf16 v[48:63], v[208:211], v[144:147], v[48:63]
    v_exp_f32 v140, v140
    v_exp_f32 v141, v141
    v_exp_f32 v142, v142
    v_exp_f32 v143, v143
    v_mfma_f32_32x32x16_bf16 v[48:63], v[212:215], v[148:151], v[48:63]
    v_cvt_pk_bf16_f32 v152, v128, v129
    v_cvt_pk_bf16_f32 v153, v130, v131
    v_cvt_pk_bf16_f32 v154, v132, v133
    v_cvt_pk_bf16_f32 v155, v134, v135
    v_cvt_pk_bf16_f32 v156, v136, v137
    v_cvt_pk_bf16_f32 v157, v138, v139
    v_cvt_pk_bf16_f32 v158, v140, v141
    v_cvt_pk_bf16_f32 v159, v142, v143
    v_or3_b32 v228, v152, v153, v154
    v_or3_b32 v229, v155, v156, v157
    v_or3_b32 v228, v228, v158, v159
    v_or_b32 v228, v228, v229
    v_and_b32 v228, s50, v228
    v_cmp_le_u32 vcc, s51, v228
    v_exp_f32 v112, v112
    v_exp_f32 v113, v113
    v_exp_f32 v114, v114
    v_exp_f32 v115, v115
    v_mfma_f32_32x32x16_bf16 v[128:143], v[176:179], v[40:43], 0
    v_exp_f32 v116, v116
    v_exp_f32 v117, v117
    v_exp_f32 v118, v118
    v_exp_f32 v119, v119
    v_mfma_f32_32x32x16_bf16 v[128:143], v[180:183], v[44:47], v[128:143]
    v_exp_f32 v120, v120
    v_exp_f32 v121, v121
    v_exp_f32 v122, v122
    v_exp_f32 v123, v123
    s_cbranch_vccnz K3_RARE9
K3_BACK9:
    v_mfma_f32_32x32x16_bf16 v[64:79], v[208:211], v[152:155], v[64:79]
    v_exp_f32 v124, v124
    v_exp_f32 v125, v125
    v_exp_f32 v126, v126
    v_exp_f32 v127, v127
    v_mfma_f32_32x32x16_bf16 v[64:79], v[212:215], v[156:159], v[64:79]
    v_cvt_pk_bf16_f32 v144, v112, v113
    v_cvt_pk_bf16_f32 v145, v114, v115
    v_cvt_pk_bf16_f32 v146, v116, v117
    v_cvt_pk_bf16_f32 v147, v118, v119
    v_cvt_pk_bf16_f32 v148, v120, v121
    v_cvt_pk_bf16_f32 v149, v122, v123
    v_cvt_pk_bf16_f32 v150, v124, v125
    v_cvt_pk_bf16_f32 v151, v126, v127
    v_or3_b32 v228, v144, v145, v146
    v_or3_b32 v229, v147, v148, v149
    v_or3_b32 v228, v228, v150, v151
    v_or_b32 v228, v228, v229
    v_and_b32 v228, s50, v228
    v_cmp_le_u32 vcc, s51, v228
    s_waitcnt vmcnt(8)
    v_exp_f32 v128, v128
    v_exp_f32 v129, v129
    v_exp_f32 v130, v130
    v_exp_f32 v131, v131
    v_mfma_f32_32x32x16_bf16 v[112:127], v[184:187], v[16:19], 0
    v_exp_f32 v132, v132
    v_exp_f32 v133, v133
    v_exp_f32 v134, v134
    v_exp_f32 v135, v135
    v_mfma_f32_32x32x16_bf16 v[112:127], v[188:191], v[20:23], v[112:127]
    v_exp_f32 v136, v136
    v_exp_f32 v137, v137
    v_exp_f32 v138, v138
    v_exp_f32 v139, v139
    s_cbranch_vccnz K3_RARE10
K3_BACK10:
    v_mfma_f32_32x32x16_bf16 v[80:95], v[208:211], v[144:147], v[80:95]
    v_exp_f32 v140, v140
    v_exp_f32 v141, v141
    v_exp_f32 v142, v142
    v_exp_f32 v143, v143
    v_mfma_f32_32x32x16_bf16 v[80:95], v[212:215], v[148:151], v[80:95]
    v_cvt_pk_bf16_f32 v152, v128, v129
    v_cvt_pk_bf16_f32 v153, v130, v131
    v_cvt_pk_bf16_f32 v154, v132, v133
    v_cvt_pk_bf16_f32 v155, v134, v135
    v_cvt_pk_bf16_f32 v156, v136, v137
    v_cvt_pk_bf16_f32 v157, v138, v139
    v_cvt_pk_bf16_f32 v158, v140, v141
    v_cvt_pk_bf16_f32 v159, v142, v143
    v_or3_b32 v228, v152, v153, v154
    v_or3_b32 v229, v155, v156, v157
    v_or3_b32 v228, v228, v158, v159
    v_or_b32 v228, v228, v229
    v_and_b32 v228, s50, v228
    v_cmp_le_u32 vcc, s51, v228
    v_exp_f32 v112, v112
    v_exp_f32 v113, v113
    v_exp_f32 v114, v114
    v_exp_f32 v115, v115
    v_mfma_f32_32x32x16_bf16 v[128:143], v[184:187], v[24:27], 0
    v_exp_f32 v116, v116
    v_exp_f32 v117, v117
    v_exp_f32 v118, v118
    v_exp_f32 v119, v119
    v_mfma_f32_32x32x16_bf16 v[128:143], v[188:191], v[28:31], v[128:143]
    v_exp_f32 v120, v120
    v_exp_f32 v121, v121
    v_exp_f32 v122, v122
    v_exp_f32 v123, v123
    s_cbranch_vccnz K3_RARE11
K3_BACK11:
    v_mfma_f32_32x32x16_bf16 v[96:111], v[208:211], v[152:155], v[96:111]
    v_exp_f32 v124, v124
    v_exp_f32 v125, v125
    v_exp_f32 v126, v126
    v_exp_f32 v127, v127
    v_mfma_f32_32x32x16_bf16 v[96:111], v[212:215], v[156:159], v[96:111]
    v_cvt_pk_bf16_f32 v144, v112, v113
    v_cvt_pk_bf16_f32 v145, v114, v115
    v_cvt_pk_bf16_f32 v146, v116, v117
    v_cvt_pk_bf16_f32 v147, v118, v119
    v_cvt_pk_bf16_f32 v148, v120, v121
    v_cvt_pk_bf16_f32 v149, v122, v123
    v_cvt_pk_bf16_f32 v150, v124, v125
    v_cvt_pk_bf16_f32 v151, v126, v127
    v_or3_b32 v228, v144, v145, v146
    v_or3_b32 v229, v147, v148, v149
    v_or3_b32 v228, v228, v150, v151
    v_or_b32 v228, v228, v229
    v_and_b32 v228, s50, v228
    v_cmp_le_u32 vcc, s51, v228
    buffer_load_dwordx4 v[176:179], v4, s[36:39], s9 offen
    buffer_load_dwordx4 v[180:183], v4, s[36:39], s9 offen offset:1024
    buffer_load_dwordx4 v[208:211], v4, s[36:39], s10 offen
    buffer_load_dwordx4 v[212:215], v4, s[36:39], s10 offen offset:1024
    s_add_u32 s9, s9, 2048
    s_add_u32 s10, s10, 2048
    v_exp_f32 v128, v128
    v_exp_f32 v129, v129
    v_exp_f32 v130, v130
    v_exp_f32 v131, v131
    v_mfma_f32_32x32x16_bf16 v[112:127], v[184:187], v[32:35], 0
    v_exp_f32 v132, v132
    v_exp_f32 v133, v133
    v_exp_f32 v134, v134
    v_exp_f32 v135, v135
    v_mfma_f32_32x32x16_bf16 v[112:127], v[188:191], v[36:39], v[112:127]
    v_exp_f32 v136, v136
    v_exp_f32 v137, v137
    v_exp_f32 v138, v138
    v_exp_f32 v139, v139
    s_cbranch_vccnz K3_RARE12
K3_BACK12:
    v_mfma_f32_32x32x16_bf16 v[48:63], v[216:219], v[144:147], v[48:63]
    v_exp_f32 v140, v140
    v_exp_f32 v141, v141
    v_exp_f32 v142, v142
    v_exp_f32 v143, v143
    v_mfma_f32_32x32x16_bf16 v[48:63], v[220:223], v[148:151], v[48:63]
    v_cvt_pk_bf16_f32 v152, v128, v129
    v_cvt_pk_bf16_f32 v153, v130, v131
    v_cvt_pk_bf16_f32 v154, v132, v133
    v_cvt_pk_bf16_f32 v155, v134, v135
    v_cvt_pk_bf16_f32 v156, v136, v137
    v_cvt_pk_bf16_f32 v157, v138, v139
    v_cvt_pk_bf16_f32 v158, v140, v141
    v_cvt_pk_bf16_f32 v159, v142, v143
    v_or3_b32 v228, v152, v153, v154
    v_or3_b32 v229, v155, v156, v157
    v_or3_b32 v228, v228, v158, v159
    v_or_b32 v228, v228, v229
    v_and_b32 v228, s50, v228
    v_cmp_le_u32 vcc, s51, v228
    v_exp_f32 v112, v112
    v_exp_f32 v113, v113
    v_exp_f32 v114, v114
    v_exp_f32 v115, v115
    v_mfma_f32_32x32x16_bf16 v[128:143], v[184:187], v[40:43], 0
    v_exp_f32 v116, v116
    v_exp_f32 v117, v117
    v_exp_f32 v118, v118
    v_exp_f32 v119, v119
    v_mfma_f32_32x32x16_bf16 v[128:143], v[188:191], v[44:47], v[128:143]
    v_exp_f32 v120, v120
    v_exp_f32 v121, v121
    v_exp_f32 v122, v122
    v_exp_f32 v123, v123
    s_cbranch_vccnz K3_RARE13
K3_BACK13:
    v_mfma_f32_32x32x16_bf16 v[64:79], v[216:219], v[152:155], v[64:79]
    v_exp_f32 v124, v124
    v_exp_f32 v125, v125
    v_exp_f32 v126, v126
    v_exp_f32 v127, v127
    v_mfma_f32_32x32x16_bf16 v[64:79], v[220:223], v[156:159], v[64:79]
    v_cvt_pk_bf16_f32 v144, v112, v113
    v_cvt_pk_bf16_f32 v145, v114, v115
    v_cvt_pk_bf16_f32 v146, v116, v117
    v_cvt_pk_bf16_f32 v147, v118, v119
    v_cvt_pk_bf16_f32 v148, v120, v121
    v_cvt_pk_bf16_f32 v149, v122, v123
    v_cvt_pk_bf16_f32 v150, v124, v125
    v_cvt_pk_bf16_f32 v151, v126, v127
    v_or3_b32 v228, v144, v145, v146
    v_or3_b32 v229, v147, v148, v149
    v_or3_b32 v228, v228, v150, v151
    v_or_b32 v228, v228, v229
    v_and_b32 v228, s50, v228
    v_cmp_le_u32 vcc, s51, v228
    s_waitcnt vmcnt(8)
    v_exp_f32 v128, v128
    v_exp_f32 v129, v129
    v_exp_f32 v130, v130
    v_exp_f32 v131, v131
    v_mfma_f32_32x32x16_bf16 v[112:127], v[160:163], v[16:19], 0
    v_exp_f32 v132, v132
    v_exp_f32 v133, v133
    v_exp_f32 v134, v134
    v_exp_f32 v135, v135
    v_mfma_f32_32x32x16_bf16 v[112:127], v[164:167], v[20:23], v[112:127]
    v_exp_f32 v136, v136
    v_exp_f32 v137, v137
    v_exp_f32 v138, v138
    v_exp_f32 v139, v139
    s_cbranch_vccnz K3_RARE14
K3_BACK14:
    v_mfma_f32_32x32x16_bf16 v[80:95], v[216:219], v[144:147], v[80:95]
    v_exp_f32 v140, v140
    v_exp_f32 v141, v141
    v_exp_f32 v142, v142
    v_exp_f32 v143, v143
    v_mfma_f32_32x32x16_bf16 v[80:95], v[220:223], v[148:151], v[80:95]
    v_cvt_pk_bf16_f32 v152, v128, v129
    v_cvt_pk_bf16_f32 v153, v130, v131
    v_cvt_pk_bf16_f32 v154, v132, v133
    v_cvt_pk_bf16_f32 v155, v134, v135
    v_cvt_pk_bf16_f32 v156, v136, v137
    v_cvt_pk_bf16_f32 v157, v138, v139
    v_cvt_pk_bf16_f32 v158, v140, v141
    v_cvt_pk_bf16_f32 v159, v142, v143
    v_or3_b32 v228, v152, v153, v154
    v_or3_b32 v229, v155, v156, v157
    v_or3_b32 v228, v228, v158, v159
    v_or_b32 v228, v228, v229
    v_and_b32 v228, s50, v228
    v_cmp_le_u32 vcc, s51, v228
    s_add_u32 s11, s11, 1
    s_cmp_lt_u32 s11, 2
    s_cbranch_scc1 K3_LOOP
    s_nop 4
    s_cbranch_vccnz K3_RARE16
K3_BACK16:
    v_mfma_f32_32x32x16_bf16 v[96:111], v[216:219], v[152:155], v[96:111]
    v_mfma_f32_32x32x16_bf16 v[96:111], v[220:223], v[156:159], v[96:111]
    s_nop 15
    s_lshr_b32 s52, s4, 2
    s_lshl_b32 s47, s52, 2
    s_cmp_eq_u32 s52, 3
    s_cselect_b32 s53, 1, 0
    s_sub_u32 s47, s47, s53
    s_lshr_b32 s53, s6, 1
    s_add_u32 s47, s47, s53
    s_cmp_ge_u32 s52, 2
    s_cselect_b32 s52, 3, 4
    s_cmp_lt_u32 s53, s52
    s_cselect_b32 s46, 1, 0
    s_cmp_eq_u32 s46, 0
    s_cbranch_scc1 K3_NOW
    s_lshl_b32 s52, s47, 5
    s_and_b32 s53, s6, 1
    s_lshl_b32 s53, s53, 4
    s_add_u32 s52, s52, s53
    s_lshl_b32 s52, s52, 10
    s_add_u32 s52, s52, 0x280000
    buffer_load_dwordx4 v[116:119], v4, s[36:39], s52 offen offset:0
    buffer_load_dwordx4 v[120:123], v4, s[36:39], s52 offen offset:1024
    buffer_load_dwordx4 v[124:127], v4, s[36:39], s52 offen offset:2048
    buffer_load_dwordx4 v[128:131], v4, s[36:39], s52 offen offset:3072
    s_add_u32 s52, s52, 4096
    buffer_load_dwordx4 v[132:135], v4, s[36:39], s52 offen offset:0
    buffer_load_dwordx4 v[136:139], v4, s[36:39], s52 offen offset:1024
    buffer_load_dwordx4 v[140:143], v4, s[36:39], s52 offen offset:2048
    buffer_load_dwordx4 v[144:147], v4, s[36:39], s52 offen offset:3072
    s_add_u32 s52, s52, 4096
    buffer_load_dwordx4 v[148:151], v4, s[36:39], s52 offen offset:0
    buffer_load_dwordx4 v[152:155], v4, s[36:39], s52 offen offset:1024
    buffer_load_dwordx4 v[156:159], v4, s[36:39], s52 offen offset:2048
    buffer_load_dwordx4 v[160:163], v4, s[36:39], s52 offen offset:3072
    s_add_u32 s52, s52, 4096
    buffer_load_dwordx4 v[164:167], v4, s[36:39], s52 offen offset:0
    buffer_load_dwordx4 v[168:171], v4, s[36:39], s52 offen offset:1024
    buffer_load_dwordx4 v[172:175], v4, s[36:39], s52 offen offset:2048
    buffer_load_dwordx4 v[176:179], v4, s[36:39], s52 offen offset:3072
K3_NOW:
    s_cmp_ge_u32 s2, 98
    s_cbranch_scc1 K3_NOSE
    s_mul_i32 s76, s2, 4682
    s_lshr_b32 s76, s76, 16
    s_mul_i32 s77, s76, 14
    s_sub_u32 s77, s2, s77
    s_cmp_ge_u32 s6, 4
    s_cbranch_scc1 K3_NOSE
    s_mov_b32 s80, s24
    s_mov_b32 s81, s25
    s_mov_b32 s82, 0x188000
    s_mov_b32 s83, 0x00020000
    v_mul_u32_u24 v248, 3584, v3
    v_lshl_add_u32 v248, v2, 4, v248
    s_lshl_b32 s78, s77, 5
    s_lshl_b32 s79, s6, 3
    s_add_u32 s78, s78, s79
    s_mul_i32 s78, s78, 3584
    s_lshl_b32 s79, s76, 9
    s_add_u32 s78, s78, s79
    s_lshl_b32 s79, s6, 12
    s_add_u32 s79, s79, 135168
    s_mov_b32 m0, s79
    s_nop 0
    buffer_load_dwordx4 v248, s[80:83], s78 offen lds
    s_add_u32 s78, s78, 7168
    s_add_u32 s79, s79, 1024
    s_mov_b32 m0, s79
    s_nop 0
    buffer_load_dwordx4 v248, s[80:83], s78 offen lds
    s_add_u32 s78, s78, 7168
    s_add_u32 s79, s79, 1024
    s_mov_b32 m0, s79
    s_nop 0
    buffer_load_dwordx4 v248, s[80:83], s78 offen lds
    s_add_u32 s78, s78, 7168
    s_add_u32 s79, s79, 1024
    s_mov_b32 m0, s79
    s_nop 0
    buffer_load_dwordx4 v248, s[80:83], s78 offen lds
    v_mov_b32 v249, 7168
    v_mov_b32 v250, 5376
    v_cmp_eq_u32 vcc, 0, v3
    s_nop 1
    v_cndmask_b32 v249, v250, v249, vcc
    v_lshl_add_u32 v249, v2, 2, v249
    s_lshl_b32 s78, s77, 7
    s_add_u32 s78, s78, 0x1a00000
    buffer_load_dword v180, v249, s[36:39], s78 offen
    s_add_u32 s78, s78, 10752
    buffer_load_dword v181, v249, s[36:39], s78 offen
    s_add_u32 s78, s78, 10752
    buffer_load_dword v182, v249, s[36:39], s78 offen
    s_add_u32 s78, s78, 10752
    buffer_load_dword v183, v249, s[36:39], s78 offen
    s_add_u32 s78, s78, 10752
    buffer_load_dword v184, v249, s[36:39], s78 offen
    s_add_u32 s78, s78, 10752
    buffer_load_dword v185, v249, s[36:39], s78 offen
    s_add_u32 s78, s78, 10752
    buffer_load_dword v186, v249, s[36:39], s78 offen
    s_add_u32 s78, s78, 10752
    buffer_load_dword v187, v249, s[36:39], s78 offen
K3_NOSE:
    v_lshlrev_b32 v5, 2, v2
    s_lshl_b32 s12, s6, 9
    v_add_u32 v6, s12, v5
    ds_write_b32 v6, v224 offset:0
    ds_write_b32 v6, v225 offset:128
    ds_write_b32 v6, v226 offset:256
    ds_write_b32 v6, v227 offset:384
    s_lshl_b32 s12, s6, 14
    s_add_u32 s12, s12, 4096
    v_add_u32 v7, s12, v4
    ds_write_b128 v7, v[48:51] offset:0
    ds_write_b128 v7, v[52:55] offset:1024
    ds_write_b128 v7, v[56:59] offset:2048
    ds_write_b128 v7, v[60:63] offset:3072
    ds_write_b128 v7, v[64:67] offset:4096
    ds_write_b128 v7, v[68:71] offset:5120
    ds_write_b128 v7, v[72:75] offset:6144
    ds_write_b128 v7, v[76:79] offset:7168
    ds_write_b128 v7, v[80:83] offset:8192
    ds_write_b128 v7, v[84:87] offset:9216
    ds_write_b128 v7, v[88:91] offset:10240
    ds_write_b128 v7, v[92:95] offset:11264
    ds_write_b128 v7, v[96:99] offset:12288
    ds_write_b128 v7, v[100:103] offset:13312
    ds_write_b128 v7, v[104:107] offset:14336
    ds_write_b128 v7, v[108:111] offset:15360
    s_lshr_b32 s13, s6, 1
    s_and_b32 s14, s6, 1
    s_lshl_b32 s15, s13, 12
    s_lshl_b32 s12, s14, 11
    s_add_u32 s12, s12, s15
    s_add_u32 s12, s12, 4096
    v_add_u32 v8, s12, v4
    v_add_u32 v9, 0x10000, v8
    s_add_u32 s15, s15, 7680
    v_lshlrev_b32 v10, 4, v2
    v_add_u32 v10, s15, v10
    v_add_u32 v11, 0x10000, v10
    s_lshl_b32 s15, s13, 7
    v_add_u32 v12, s15, v5
    s_waitcnt lgkmcnt(0)
    s_barrier
    ds_read_b32 v104, v12 offset:0
    ds_read_b32 v105, v12 offset:512
    ds_read_b32 v106, v12 offset:1024
    ds_read_b32 v107, v12 offset:1536
    ds_read_b32 v108, v12 offset:2048
    ds_read_b32 v109, v12 offset:2560
    ds_read_b32 v110, v12 offset:3072
    ds_read_b32 v111, v12 offset:3584
    ds_read_b32 v96, v10 offset:0
    ds_read_b32 v97, v10 offset:16384
    ds_read_b32 v98, v10 offset:32768
    ds_read_b32 v99, v10 offset:49152
    ds_read_b32 v100, v11 offset:0
    ds_read_b32 v101, v11 offset:16384
    ds_read_b32 v102, v11 offset:32768
    ds_read_b32 v103, v11 offset:49152
    ds_read_b128 v[16:19], v8 offset:0
    ds_read_b128 v[20:23], v8 offset:1024
    ds_read_b128 v[24:27], v8 offset:16384
    ds_read_b128 v[28:31], v8 offset:17408
    ds_read_b128 v[32:35], v8 offset:32768
    ds_read_b128 v[36:39], v8 offset:33792
    ds_read_b128 v[40:43], v8 offset:49152
    ds_read_b128 v[44:47], v8 offset:50176
    ds_read_b128 v[48:51], v9 offset:0
    ds_read_b128 v[52:55], v9 offset:1024
    ds_read_b128 v[56:59], v9 offset:16384
    ds_read_b128 v[60:63], v9 offset:17408
    ds_read_b128 v[64:67], v9 offset:32768
    ds_read_b128 v[68:71], v9 offset:33792
    ds_read_b128 v[72:75], v9 offset:49152
    ds_read_b128 v[76:79], v9 offset:50176
    s_waitcnt lgkmcnt(15)
    v_max3_f32 v112, v104, v105, v106
    v_max3_f32 v112, v112, v107, v108
    v_max3_f32 v112, v112, v109, v110
    v_max_f32 v112, v112, v111
    v_sub_f32 v104, v104, v112
    v_sub_f32 v105, v105, v112
    v_sub_f32 v106, v106, v112
    v_sub_f32 v107, v107, v112
    v_sub_f32 v108, v108, v112
    v_sub_f32 v109, v109, v112
    v_sub_f32 v110, v110, v112
    v_sub_f32 v111, v111, v112
    v_exp_f32 v104, v104
    v_exp_f32 v105, v105
    v_exp_f32 v106, v106
    v_exp_f32 v107, v107
    v_exp_f32 v108, v108
    v_exp_f32 v109, v109
    v_exp_f32 v110, v110
    v_exp_f32 v111, v111
    s_waitcnt lgkmcnt(0)
    v_mul_f32 v96, v104, v96
    v_mul_f32 v16, v104, v16
    v_mul_f32 v17, v104, v17
    v_mul_f32 v18, v104, v18
    v_mul_f32 v19, v104, v19
    v_mul_f32 v20, v104, v20
    v_mul_f32 v21, v104, v21
    v_mul_f32 v22, v104, v22
    v_mul_f32 v23, v104, v23
    v_fmac_f32 v16, v105, v24
    v_fmac_f32 v17, v105, v25
    v_fmac_f32 v18, v105, v26
    v_fmac_f32 v19, v105, v27
    v_fmac_f32 v20, v105, v28
    v_fmac_f32 v21, v105, v29
    v_fmac_f32 v22, v105, v30
    v_fmac_f32 v23, v105, v31
    v_fmac_f32 v96, v105, v97
    v_fmac_f32 v16, v106, v32
    v_fmac_f32 v17, v106, v33
    v_fmac_f32 v18, v106, v34
    v_fmac_f32 v19, v106, v35
    v_fmac_f32 v20, v106, v36
    v_fmac_f32 v21, v106, v37
    v_fmac_f32 v22, v106, v38
    v_fmac_f32 v23, v106, v39
    v_fmac_f32 v96, v106, v98
    v_fmac_f32 v16, v107, v40
    v_fmac_f32 v17, v107, v41
    v_fmac_f32 v18, v107, v42
    v_fmac_f32 v19, v107, v43
    v_fmac_f32 v20, v107, v44
    v_fmac_f32 v21, v107, v45
    v_fmac_f32 v22, v107, v46
    v_fmac_f32 v23, v107, v47
    v_fmac_f32 v96, v107, v99
    v_fmac_f32 v16, v108, v48
    v_fmac_f32 v17, v108, v49
    v_fmac_f32 v18, v108, v50
    v_fmac_f32 v19, v108, v51
    v_fmac_f32 v20, v108, v52
    v_fmac_f32 v21, v108, v53
    v_fmac_f32 v22, v108, v54
    v_fmac_f32 v23, v108, v55
    v_fmac_f32 v96, v108, v100
    v_fmac_f32 v16, v109, v56
    v_fmac_f32 v17, v109, v57
    v_fmac_f32 v18, v109, v58
    v_fmac_f32 v19, v109, v59
    v_fmac_f32 v20, v109, v60
    v_fmac_f32 v21, v109, v61
    v_fmac_f32 v22, v109, v62
    v_fmac_f32 v23, v109, v63
    v_fmac_f32 v96, v109, v101
    v_fmac_f32 v16, v110, v64
    v_fmac_f32 v17, v110, v65
    v_fmac_f32 v18, v110, v66
    v_fmac_f32 v19, v110, v67
    v_fmac_f32 v20, v110, v68
    v_fmac_f32 v21, v110, v69
    v_fmac_f32 v22, v110, v70
    v_fmac_f32 v23, v110, v71
    v_fmac_f32 v96, v110, v102
    v_fmac_f32 v16, v111, v72
    v_fmac_f32 v17, v111, v73
    v_fmac_f32 v18, v111, v74
    v_fmac_f32 v19, v111, v75
    v_fmac_f32 v20, v111, v76
    v_fmac_f32 v21, v111, v77
    v_fmac_f32 v22, v111, v78
    v_fmac_f32 v23, v111, v79
    v_fmac_f32 v96, v111, v103
    v_rcp_f32 v96, v96
    s_nop 0
    v_mul_f32 v16, v96, v16
    v_mul_f32 v17, v96, v17
    v_mul_f32 v18, v96, v18
    v_mul_f32 v19, v96, v19
    v_mul_f32 v20, v96, v20
    v_mul_f32 v21, v96, v21
    v_mul_f32 v22, v96, v22
    v_mul_f32 v23, v96, v23
    v_cvt_pk_bf16_f32 v16, v16, v17
    v_cvt_pk_bf16_f32 v17, v18, v19
    v_cvt_pk_bf16_f32 v18, v20, v21
    v_cvt_pk_bf16_f32 v19, v22, v23
    s_lshl_b32 s12, s3, 2
    s_add_u32 s12, s12, s13
    s_lshl_b32 s12, s12, 4
    s_add_u32 s12, s12, s4
    s_lshl_b32 s12, s12, 1
    s_add_u32 s12, s12, s14
    s_lshl_b32 s12, s12, 10
    s_add_u32 s12, s12, 0xd00000
    buffer_store_dwordx4 v[16:19], v4, s[36:39], s12 offen sc1
    s_waitcnt vmcnt(0)
    s_barrier
    s_lshl_b32 s52, s3, 7
    s_add_u32 s52, s52, 0x1a80000
    v_mov_b32 v5, 0
    v_mov_b32 v6, 1
    s_cmp_lg_u32 s6, 0
    s_cbranch_scc1 K3_NOSIG
    v_cmp_eq_u32 vcc, 0, v1
    s_and_saveexec_b64 s[54:55], vcc
    buffer_atomic_add v6, v5, s[36:39], s52 offen sc1
    s_mov_b64 exec, s[54:55]
K3_NOSIG:
    s_cmp_ge_u32 s2, 98
    s_cbranch_scc1 K3_NOSL
    s_cmp_ge_u32 s6, 4
    s_cbranch_scc1 K3_SL1
    v_add_f32 v180, v180, v184
    v_add_f32 v181, v181, v185
    v_add_f32 v182, v182, v186
    v_add_f32 v183, v183, v187
    v_add_f32 v180, v180, v182
    v_add_f32 v181, v181, v183
    v_add_f32 v180, v180, v181
    v_cvt_pk_bf16_f32 v180, v180, v180
    v_lshlrev_b32 v180, 16, v180
    v_add_f32 v181, 1.0, v180
    v_cvt_pk_bf16_f32 v181, v181, v181
    v_lshlrev_b32 v181, 16, v181
    v_cmp_eq_u32 vcc, 0, v3
    s_nop 1
    v_cndmask_b32 v180, v180, v181, vcc
    s_lshl_b32 s78, s6, 8
    s_add_u32 s78, s78, 151552
    v_lshlrev_b32 v91, 2, v1
    v_add_u32 v91, s78, v91
    ds_write_b32 v91, v180
    v_lshlrev_b32 v92, 4, v3
    v_add_u32 v92, s78, v92
    s_waitcnt lgkmcnt(0)
    ds_read_b128 v[48:51], v92 offset:0
    ds_read_b128 v[52:55], v92 offset:32
    ds_read_b128 v[56:59], v92 offset:64
    ds_read_b128 v[60:63], v92 offset:96
    ds_read_b128 v[64:67], v92 offset:128
    ds_read_b128 v[68:71], v92 offset:160
    ds_read_b128 v[72:75], v92 offset:192
    ds_read_b128 v[76:79], v92 offset:224
    v_bfe_u32 v93, v0, 2, 2
    v_mad_u32_u24 v93, v3, 4, v93
    v_lshlrev_b32 v93, 9, v93
    v_and_b32 v94, 3, v0
    v_lshl_add_u32 v93, v94, 3, v93
    v_bfe_u32 v94, v0, 4, 1
    v_lshl_add_u32 v93, v94, 5, v93
    s_lshl_b32 s78, s6, 7
    s_add_u32 s78, s78, 135168
    v_add_u32 v93, s78, v93
    ds_read_b64_tr_b16 v[32:33], v93 offset:0
    ds_read_b64_tr_b16 v[34:35], v93 offset:4096
    ds_read_b64_tr_b16 v[36:37], v93 offset:8192
    ds_read_b64_tr_b16 v[38:39], v93 offset:12288
    ds_read_b64_tr_b16 v[40:41], v93 offset:64
    ds_read_b64_tr_b16 v[42:43], v93 offset:4160
    ds_read_b64_tr_b16 v[44:45], v93 offset:8256
    ds_read_b64_tr_b16 v[46:47], v93 offset:12352
    v_mov_b32 v90, 0x3f803f80
    v_lshlrev_b32 v95, 6, v1
    s_lshl_b32 s78, s76, 3
    s_lshl_b32 s79, s6, 1
    s_add_u32 s78, s78, s79
    s_waitcnt lgkmcnt(0)
    v_mov_b32 v88, 0
    v_mov_b32 v89, 0
    v_lshlrev_b32 v80, 16, v32
    v_and_b32 v81, 0xffff0000, v32
    v_lshlrev_b32 v82, 16, v33
    v_and_b32 v83, 0xffff0000, v33
    v_lshlrev_b32 v84, 16, v34
    v_and_b32 v85, 0xffff0000, v34
    v_lshlrev_b32 v86, 16, v35
    v_and_b32 v87, 0xffff0000, v35
    v_fmac_f32 v89, v80, v64
    v_fmac_f32 v89, v81, v65
    v_fmac_f32 v89, v82, v66
    v_fmac_f32 v89, v83, v67
    v_fmac_f32 v89, v84, v68
    v_fmac_f32 v89, v85, v69
    v_fmac_f32 v89, v86, v70
    v_fmac_f32 v89, v87, v71
    v_mul_f32 v80, v80, v48
    v_mul_f32 v81, v81, v49
    v_mul_f32 v82, v82, v50
    v_mul_f32 v83, v83, v51
    v_mul_f32 v84, v84, v52
    v_mul_f32 v85, v85, v53
    v_mul_f32 v86, v86, v54
    v_mul_f32 v87, v87, v55
    v_cvt_pk_bf16_f32 v32, v80, v81
    v_cvt_pk_bf16_f32 v33, v82, v83
    v_cvt_pk_bf16_f32 v34, v84, v85
    v_cvt_pk_bf16_f32 v35, v86, v87
    v_dot2_f32_bf16 v88, v32, v90, v88
    v_dot2_f32_bf16 v88, v33, v90, v88
    v_dot2_f32_bf16 v88, v34, v90, v88
    v_dot2_f32_bf16 v88, v35, v90, v88
    s_add_u32 s79, s78, 0
    s_mul_i32 s79, s79, 28
    s_lshl_b32 s84, s77, 1
    s_add_u32 s79, s79, s84
    s_add_u32 s79, s79, 0
    s_lshl_b32 s79, s79, 10
    s_add_u32 s79, s79, 0x300000
    buffer_store_dwordx4 v[32:35], v4, s[36:39], s79 offen sc1
    v_lshlrev_b32 v80, 16, v36
    v_and_b32 v81, 0xffff0000, v36
    v_lshlrev_b32 v82, 16, v37
    v_and_b32 v83, 0xffff0000, v37
    v_lshlrev_b32 v84, 16, v38
    v_and_b32 v85, 0xffff0000, v38
    v_lshlrev_b32 v86, 16, v39
    v_and_b32 v87, 0xffff0000, v39
    v_fmac_f32 v89, v80, v72
    v_fmac_f32 v89, v81, v73
    v_fmac_f32 v89, v82, v74
    v_fmac_f32 v89, v83, v75
    v_fmac_f32 v89, v84, v76
    v_fmac_f32 v89, v85, v77
    v_fmac_f32 v89, v86, v78
    v_fmac_f32 v89, v87, v79
    v_mul_f32 v80, v80, v56
    v_mul_f32 v81, v81, v57
    v_mul_f32 v82, v82, v58
    v_mul_f32 v83, v83, v59
    v_mul_f32 v84, v84, v60
    v_mul_f32 v85, v85, v61
    v_mul_f32 v86, v86, v62
    v_mul_f32 v87, v87, v63
    v_cvt_pk_bf16_f32 v36, v80, v81
    v_cvt_pk_bf16_f32 v37, v82, v83
    v_cvt_pk_bf16_f32 v38, v84, v85
    v_cvt_pk_bf16_f32 v39, v86, v87
    v_dot2_f32_bf16 v88, v36, v90, v88
    v_dot2_f32_bf16 v88, v37, v90, v88
    v_dot2_f32_bf16 v88, v38, v90, v88
    v_dot2_f32_bf16 v88, v39, v90, v88
    s_add_u32 s79, s78, 0
    s_mul_i32 s79, s79, 28
    s_lshl_b32 s84, s77, 1
    s_add_u32 s79, s79, s84
    s_add_u32 s79, s79, 1
    s_lshl_b32 s79, s79, 10
    s_add_u32 s79, s79, 0x300000
    buffer_store_dwordx4 v[36:39], v4, s[36:39], s79 offen sc1
    v_permlane32_swap_b32 v88, v89
    v_add_f32 v88, v88, v89
    s_add_u32 s79, s78, 0
    s_lshl_b32 s79, s79, 12
    s_lshl_b32 s84, s77, 2
    s_add_u32 s79, s79, s84
    s_add_u32 s79, s79, 0x40000
    buffer_store_dword v88, v95, s[36:39], s79 offen
    v_mov_b32 v88, 0
    v_mov_b32 v89, 0
    v_lshlrev_b32 v80, 16, v40
    v_and_b32 v81, 0xffff0000, v40
    v_lshlrev_b32 v82, 16, v41
    v_and_b32 v83, 0xffff0000, v41
    v_lshlrev_b32 v84, 16, v42
    v_and_b32 v85, 0xffff0000, v42
    v_lshlrev_b32 v86, 16, v43
    v_and_b32 v87, 0xffff0000, v43
    v_fmac_f32 v89, v80, v64
    v_fmac_f32 v89, v81, v65
    v_fmac_f32 v89, v82, v66
    v_fmac_f32 v89, v83, v67
    v_fmac_f32 v89, v84, v68
    v_fmac_f32 v89, v85, v69
    v_fmac_f32 v89, v86, v70
    v_fmac_f32 v89, v87, v71
    v_mul_f32 v80, v80, v48
    v_mul_f32 v81, v81, v49
    v_mul_f32 v82, v82, v50
    v_mul_f32 v83, v83, v51
    v_mul_f32 v84, v84, v52
    v_mul_f32 v85, v85, v53
    v_mul_f32 v86, v86, v54
    v_mul_f32 v87, v87, v55
    v_cvt_pk_bf16_f32 v40, v80, v81
    v_cvt_pk_bf16_f32 v41, v82, v83
    v_cvt_pk_bf16_f32 v42, v84, v85
    v_cvt_pk_bf16_f32 v43, v86, v87
    v_dot2_f32_bf16 v88, v40, v90, v88
    v_dot2_f32_bf16 v88, v41, v90, v88
    v_dot2_f32_bf16 v88, v42, v90, v88
    v_dot2_f32_bf16 v88, v43, v90, v88
    s_add_u32 s79, s78, 1
    s_mul_i32 s79, s79, 28
    s_lshl_b32 s84, s77, 1
    s_add_u32 s79, s79, s84
    s_add_u32 s79, s79, 0
    s_lshl_b32 s79, s79, 10
    s_add_u32 s79, s79, 0x300000
    buffer_store_dwordx4 v[40:43], v4, s[36:39], s79 offen sc1
    v_lshlrev_b32 v80, 16, v44
    v_and_b32 v81, 0xffff0000, v44
    v_lshlrev_b32 v82, 16, v45
    v_and_b32 v83, 0xffff0000, v45
    v_lshlrev_b32 v84, 16, v46
    v_and_b32 v85, 0xffff0000, v46
    v_lshlrev_b32 v86, 16, v47
    v_and_b32 v87, 0xffff0000, v47
    v_fmac_f32 v89, v80, v72
    v_fmac_f32 v89, v81, v73
    v_fmac_f32 v89, v82, v74
    v_fmac_f32 v89, v83, v75
    v_fmac_f32 v89, v84, v76
    v_fmac_f32 v89, v85, v77
    v_fmac_f32 v89, v86, v78
    v_fmac_f32 v89, v87, v79
    v_mul_f32 v80, v80, v56
    v_mul_f32 v81, v81, v57
    v_mul_f32 v82, v82, v58
    v_mul_f32 v83, v83, v59
    v_mul_f32 v84, v84, v60
    v_mul_f32 v85, v85, v61
    v_mul_f32 v86, v86, v62
    v_mul_f32 v87, v87, v63
    v_cvt_pk_bf16_f32 v44, v80, v81
    v_cvt_pk_bf16_f32 v45, v82, v83
    v_cvt_pk_bf16_f32 v46, v84, v85
    v_cvt_pk_bf16_f32 v47, v86, v87
    v_dot2_f32_bf16 v88, v44, v90, v88
    v_dot2_f32_bf16 v88, v45, v90, v88
    v_dot2_f32_bf16 v88, v46, v90, v88
    v_dot2_f32_bf16 v88, v47, v90, v88
    s_add_u32 s79, s78, 1
    s_mul_i32 s79, s79, 28
    s_lshl_b32 s84, s77, 1
    s_add_u32 s79, s79, s84
    s_add_u32 s79, s79, 1
    s_lshl_b32 s79, s79, 10
    s_add_u32 s79, s79, 0x300000
    buffer_store_dwordx4 v[44:47], v4, s[36:39], s79 offen sc1
    v_permlane32_swap_b32 v88, v89
    v_add_f32 v88, v88, v89
    s_add_u32 s79, s78, 1
    s_lshl_b32 s79, s79, 12
    s_lshl_b32 s84, s77, 2
    s_add_u32 s79, s79, s84
    s_add_u32 s79, s79, 0x40000
    buffer_store_dword v88, v95, s[36:39], s79 offen
K3_SL1:
K3_NOSL:
    s_and_b32 s56, s4, 3
    s_lshl_b32 s57, s3, 2
    s_add_u32 s56, s56, s57
    s_min_u32 s47, s47, 13
    v_mul_u32_u24 v7, 896, v2
    v_lshl_add_u32 v7, v3, 3, v7
    s_mul_i32 s57, s56, 28672
    s_lshl_b32 s58, s47, 6
    s_add_u32 s57, s57, s58
    buffer_load_dwordx2 v[16:17], v7, s[40:43], s57 offen offset:0
    buffer_load_dwordx2 v[18:19], v7, s[40:43], s57 offen offset:16
    buffer_load_dwordx2 v[20:21], v7, s[40:43], s57 offen offset:32
    buffer_load_dwordx2 v[22:23], v7, s[40:43], s57 offen offset:48
    v_lshlrev_b32 v9, 2, v2
    s_lshl_b32 s57, s47, 7
    s_add_u32 s57, s57, 0x1a00e00
    buffer_load_dword v24, v9, s[36:39], s57 offen
    s_add_u32 s57, s57, 10752
    buffer_load_dword v25, v9, s[36:39], s57 offen
    s_add_u32 s57, s57, 10752
    buffer_load_dword v26, v9, s[36:39], s57 offen
    s_add_u32 s57, s57, 10752
    buffer_load_dword v27, v9, s[36:39], s57 offen
    s_add_u32 s57, s57, 10752
    buffer_load_dword v28, v9, s[36:39], s57 offen
    s_add_u32 s57, s57, 10752
    buffer_load_dword v29, v9, s[36:39], s57 offen
    s_add_u32 s57, s57, 10752
    buffer_load_dword v30, v9, s[36:39], s57 offen
    s_add_u32 s57, s57, 10752
    buffer_load_dword v31, v9, s[36:39], s57 offen
    s_cmp_lg_u32 s6, 0
    s_cbranch_scc1 K3_POLLED
K3_POLL:
    buffer_load_dword v8, v5, s[36:39], s52 offen sc1
    s_waitcnt vmcnt(0)
    v_readfirstlane_b32 s58, v8
    s_cmp_ge_u32 s58, 16
    s_cbranch_scc1 K3_POLLED
    s_sleep 2
    s_branch K3_POLL
K3_POLLED:
    s_barrier
    s_lshl_b32 s57, s56, 5
    s_lshl_b32 s58, s6, 2
    s_add_u32 s57, s57, s58
    s_lshl_b32 s57, s57, 10
    s_add_u32 s57, s57, 0xd00000
    buffer_load_dwordx4 v[192:195], v4, s[36:39], s57 offen offset:0 sc1
    buffer_load_dwordx4 v[196:199], v4, s[36:39], s57 offen offset:1024 sc1
    buffer_load_dwordx4 v[200:203], v4, s[36:39], s57 offen offset:2048 sc1
    buffer_load_dwordx4 v[204:207], v4, s[36:39], s57 offen offset:3072 sc1
    s_lshl_b32 s58, s6, 12
    v_add_u32 v8, s58, v4
    s_waitcnt vmcnt(3)
    ds_write_b128 v8, v[192:195] offset:0
    s_waitcnt vmcnt(2)
    ds_write_b128 v8, v[196:199] offset:1024
    s_waitcnt vmcnt(1)
    ds_write_b128 v8, v[200:203] offset:2048
    s_waitcnt vmcnt(0)
    ds_write_b128 v8, v[204:207] offset:3072
    s_waitcnt lgkmcnt(0)
    s_barrier
    s_lshl_b32 s58, s14, 14
    v_add_u32 v8, s58, v4
    ds_read_b128 v[192:195], v8 offset:0
    ds_read_b128 v[196:199], v8 offset:1024
    ds_read_b128 v[200:203], v8 offset:2048
    ds_read_b128 v[204:207], v8 offset:3072
    ds_read_b128 v[208:211], v8 offset:4096
    ds_read_b128 v[212:215], v8 offset:5120
    ds_read_b128 v[216:219], v8 offset:6144
    ds_read_b128 v[220:223], v8 offset:7168
    ds_read_b128 v[224:227], v8 offset:8192
    ds_read_b128 v[228:231], v8 offset:9216
    ds_read_b128 v[232:235], v8 offset:10240
    ds_read_b128 v[236:239], v8 offset:11264
    ds_read_b128 v[240:243], v8 offset:12288
    ds_read_b128 v[244:247], v8 offset:13312
    ds_read_b128 v[248:251], v8 offset:14336
    ds_read_b128 v[252:255], v8 offset:15360
    s_waitcnt lgkmcnt(15)
    v_mfma_f32_32x32x16_bf16 v[32:47], v[116:119], v[192:195], 0
    s_waitcnt lgkmcnt(14)
    v_mfma_f32_32x32x16_bf16 v[32:47], v[120:123], v[196:199], v[32:47]
    s_waitcnt lgkmcnt(13)
    v_mfma_f32_32x32x16_bf16 v[32:47], v[124:127], v[200:203], v[32:47]
    s_waitcnt lgkmcnt(12)
    v_mfma_f32_32x32x16_bf16 v[32:47], v[128:131], v[204:207], v[32:47]
    s_waitcnt lgkmcnt(11)
    v_mfma_f32_32x32x16_bf16 v[32:47], v[132:135], v[208:211], v[32:47]
    s_waitcnt lgkmcnt(10)
    v_mfma_f32_32x32x16_bf16 v[32:47], v[136:139], v[212:215], v[32:47]
    s_waitcnt lgkmcnt(9)
    v_mfma_f32_32x32x16_bf16 v[32:47], v[140:143], v[216:219], v[32:47]
    s_waitcnt lgkmcnt(8)
    v_mfma_f32_32x32x16_bf16 v[32:47], v[144:147], v[220:223], v[32:47]
    s_waitcnt lgkmcnt(7)
    v_mfma_f32_32x32x16_bf16 v[32:47], v[148:151], v[224:227], v[32:47]
    s_waitcnt lgkmcnt(6)
    v_mfma_f32_32x32x16_bf16 v[32:47], v[152:155], v[228:231], v[32:47]
    s_waitcnt lgkmcnt(5)
    v_mfma_f32_32x32x16_bf16 v[32:47], v[156:159], v[232:235], v[32:47]
    s_waitcnt lgkmcnt(4)
    v_mfma_f32_32x32x16_bf16 v[32:47], v[160:163], v[236:239], v[32:47]
    s_waitcnt lgkmcnt(3)
    v_mfma_f32_32x32x16_bf16 v[32:47], v[164:167], v[240:243], v[32:47]
    s_waitcnt lgkmcnt(2)
    v_mfma_f32_32x32x16_bf16 v[32:47], v[168:171], v[244:247], v[32:47]
    s_waitcnt lgkmcnt(1)
    v_mfma_f32_32x32x16_bf16 v[32:47], v[172:175], v[248:251], v[32:47]
    s_waitcnt lgkmcnt(0)
    v_mfma_f32_32x32x16_bf16 v[32:47], v[176:179], v[252:255], v[32:47]
    s_nop 11
    s_lshl_b32 s57, s13, 12
    s_add_u32 s57, s57, 32768
    v_add_u32 v8, s57, v4
    s_cmp_eq_u32 s14, 0
    s_cbranch_scc1 K3_KH0A
    ds_write_b128 v8, v[32:35] offset:0
    ds_write_b128 v8, v[36:39] offset:1024
    ds_write_b128 v8, v[40:43] offset:2048
    ds_write_b128 v8, v[44:47] offset:3072
    s_waitcnt lgkmcnt(0)
K3_KH0A:
    s_barrier
    s_cmp_lg_u32 s14, 0
    s_cbranch_scc1 K3_END
    s_cmp_eq_u32 s46, 0
    s_cbranch_scc1 K3_END
    ds_read_b128 v[48:51], v8 offset:0
    ds_read_b128 v[52:55], v8 offset:1024
    ds_read_b128 v[56:59], v8 offset:2048
    ds_read_b128 v[60:63], v8 offset:3072
    v_add_f32 v24, v24, v28
    v_add_f32 v25, v25, v29
    v_add_f32 v26, v26, v30
    v_add_f32 v27, v27, v31
    v_add_f32 v24, v24, v26
    v_add_f32 v25, v25, v27
    v_add_f32 v24, v24, v25
    v_cvt_pk_bf16_f32 v24, v24, v24
    v_lshlrev_b32 v24, 16, v24
    s_lshl_b32 s57, s6, 7
    s_add_u32 s57, s57, 57344
    v_add_u32 v9, s57, v9
    v_lshlrev_b32 v10, 4, v3
    v_add_u32 v10, s57, v10
    ds_write_b32 v9, v24
    s_waitcnt lgkmcnt(0)
    ds_read_b128 v[64:67], v10 offset:0
    ds_read_b128 v[68:71], v10 offset:32
    ds_read_b128 v[72:75], v10 offset:64
    ds_read_b128 v[76:79], v10 offset:96
    v_add_f32 v32, v32, v48
    v_add_f32 v33, v33, v49
    v_add_f32 v34, v34, v50
    v_add_f32 v35, v35, v51
    v_add_f32 v36, v36, v52
    v_add_f32 v37, v37, v53
    v_add_f32 v38, v38, v54
    v_add_f32 v39, v39, v55
    v_add_f32 v40, v40, v56
    v_add_f32 v41, v41, v57
    v_add_f32 v42, v42, v58
    v_add_f32 v43, v43, v59
    v_add_f32 v44, v44, v60
    v_add_f32 v45, v45, v61
    v_add_f32 v46, v46, v62
    v_add_f32 v47, v47, v63
    s_waitcnt lgkmcnt(0)
    v_lshlrev_b32 v80, 16, v16
    v_fma_f32 v32, v64, v32, v80
    v_and_b32 v80, 0xffff0000, v16
    v_fma_f32 v33, v65, v33, v80
    v_lshlrev_b32 v80, 16, v17
    v_fma_f32 v34, v66, v34, v80
    v_and_b32 v80, 0xffff0000, v17
    v_fma_f32 v35, v67, v35, v80
    v_lshlrev_b32 v80, 16, v18
    v_fma_f32 v36, v68, v36, v80
    v_and_b32 v80, 0xffff0000, v18
    v_fma_f32 v37, v69, v37, v80
    v_lshlrev_b32 v80, 16, v19
    v_fma_f32 v38, v70, v38, v80
    v_and_b32 v80, 0xffff0000, v19
    v_fma_f32 v39, v71, v39, v80
    v_lshlrev_b32 v80, 16, v20
    v_fma_f32 v40, v72, v40, v80
    v_and_b32 v80, 0xffff0000, v20
    v_fma_f32 v41, v73, v41, v80
    v_lshlrev_b32 v80, 16, v21
    v_fma_f32 v42, v74, v42, v80
    v_and_b32 v80, 0xffff0000, v21
    v_fma_f32 v43, v75, v43, v80
    v_lshlrev_b32 v80, 16, v22
    v_fma_f32 v44, v76, v44, v80
    v_and_b32 v80, 0xffff0000, v22
    v_fma_f32 v45, v77, v45, v80
    v_lshlrev_b32 v80, 16, v23
    v_fma_f32 v46, v78, v46, v80
    v_and_b32 v80, 0xffff0000, v23
    v_fma_f32 v47, v79, v47, v80
    v_cvt_pk_bf16_f32 v32, v32, v33
    v_cvt_pk_bf16_f32 v33, v34, v35
    v_cvt_pk_bf16_f32 v34, v36, v37
    v_cvt_pk_bf16_f32 v35, v38, v39
    v_cvt_pk_bf16_f32 v36, v40, v41
    v_cvt_pk_bf16_f32 v37, v42, v43
    v_cvt_pk_bf16_f32 v38, v44, v45
    v_cvt_pk_bf16_f32 v39, v46, v47
    s_mul_i32 s57, s56, 14
    s_add_u32 s57, s57, s47
    s_lshl_b32 s57, s57, 11
    s_add_u32 s57, s57, 0xf00000
    buffer_store_dwordx4 v[32:35], v4, s[36:39], s57 offen sc1
    buffer_store_dwordx4 v[36:39], v4, s[36:39], s57 offen offset:1024 sc1
    v_mov_b32 v81, 0
    v_mov_b32 v82, 0
    v_mov_b32 v83, 0x3f803f80
    v_dot2_f32_bf16 v81, v32, v83, v81
    v_dot2_f32_bf16 v82, v32, v32, v82
    v_dot2_f32_bf16 v81, v33, v83, v81
    v_dot2_f32_bf16 v82, v33, v33, v82
    v_dot2_f32_bf16 v81, v34, v83, v81
    v_dot2_f32_bf16 v82, v34, v34, v82
    v_dot2_f32_bf16 v81, v35, v83, v81
    v_dot2_f32_bf16 v82, v35, v35, v82
    v_dot2_f32_bf16 v81, v36, v83, v81
    v_dot2_f32_bf16 v82, v36, v36, v82
    v_dot2_f32_bf16 v81, v37, v83, v81
    v_dot2_f32_bf16 v82, v37, v37, v82
    v_dot2_f32_bf16 v81, v38, v83, v81
    v_dot2_f32_bf16 v82, v38, v38, v82
    v_dot2_f32_bf16 v81, v39, v83, v81
    v_dot2_f32_bf16 v82, v39, v39, v82
    s_nop 2
    v_permlane32_swap_b32 v81, v82
    v_add_f32 v81, v81, v82
    v_lshlrev_b32 v7, 7, v2
    v_lshl_add_u32 v7, v3, 2, v7
    s_lshl_b32 s57, s56, 12
    s_lshl_b32 s58, s47, 3
    s_add_u32 s57, s57, s58
    s_add_u32 s57, s57, 0x80000
    buffer_store_dword v81, v7, s[36:39], s57 offen
    s_endpgm
K3_RARE0:
    s_nop 7
    v_mfma_f32_32x32x16_bf16 v[232:247], v[160:163], v[16:19], 0
    v_mfma_f32_32x32x16_bf16 v[232:247], v[164:167], v[20:23], v[232:247]
    s_nop 15
    v_max3_f32 v228, v232, v233, v234
    v_max3_f32 v228, v228, v235, v236
    v_max3_f32 v228, v228, v237, v238
    v_max3_f32 v228, v228, v239, v240
    v_max3_f32 v228, v228, v241, v242
    v_max3_f32 v228, v228, v243, v244
    v_max3_f32 v228, v228, v245, v246
    v_max_f32 v228, v228, v247
    v_mov_b32 v229, v228
    s_nop 1
    v_permlane32_swap_b32 v228, v229
    v_max_f32 v228, v228, v229
    v_add_f32 v228, s49, v228
    v_max_f32 v228, s48, v228
    v_add_f32 v229, v224, v228
    v_cvt_pk_bf16_f32 v230, v229, v229
    v_lshlrev_b32 v230, 16, v230
    v_sub_f32 v229, v229, v230
    v_cvt_pk_bf16_f32 v231, v230, v229
    v_and_b32 v229, 0xffff0000, v231
    v_add_f32 v229, v229, v230
    v_sub_f32 v228, v229, v224
    v_mov_b32 v224, v229
    v_xor_b32 v231, 0x80008000, v231
    v_cndmask_b32 v22, v22, v231, s[44:45]
    v_max_f32 v229, 0, v228
    v_sub_f32 v229, 0, v229
    v_exp_f32 v229, v229
    s_nop 0
    v_mul_f32 v48, v229, v48
    v_mul_f32 v49, v229, v49
    v_mul_f32 v50, v229, v50
    v_mul_f32 v51, v229, v51
    v_mul_f32 v52, v229, v52
    v_mul_f32 v53, v229, v53
    v_mul_f32 v54, v229, v54
    v_mul_f32 v55, v229, v55
    v_mul_f32 v56, v229, v56
    v_mul_f32 v57, v229, v57
    v_mul_f32 v58, v229, v58
    v_mul_f32 v59, v229, v59
    v_mul_f32 v60, v229, v60
    v_mul_f32 v61, v229, v61
    v_mul_f32 v62, v229, v62
    v_mul_f32 v63, v229, v63
    v_sub_f32 v232, v232, v228
    v_sub_f32 v233, v233, v228
    v_sub_f32 v234, v234, v228
    v_sub_f32 v235, v235, v228
    v_sub_f32 v236, v236, v228
    v_sub_f32 v237, v237, v228
    v_sub_f32 v238, v238, v228
    v_sub_f32 v239, v239, v228
    v_sub_f32 v240, v240, v228
    v_sub_f32 v241, v241, v228
    v_sub_f32 v242, v242, v228
    v_sub_f32 v243, v243, v228
    v_sub_f32 v244, v244, v228
    v_sub_f32 v245, v245, v228
    v_sub_f32 v246, v246, v228
    v_sub_f32 v247, v247, v228
    v_exp_f32 v232, v232
    v_exp_f32 v233, v233
    v_exp_f32 v234, v234
    v_exp_f32 v235, v235
    v_exp_f32 v236, v236
    v_exp_f32 v237, v237
    v_exp_f32 v238, v238
    v_exp_f32 v239, v239
    v_exp_f32 v240, v240
    v_exp_f32 v241, v241
    v_exp_f32 v242, v242
    v_exp_f32 v243, v243
    v_exp_f32 v244, v244
    v_exp_f32 v245, v245
    v_exp_f32 v246, v246
    v_exp_f32 v247, v247
    v_cvt_pk_bf16_f32 v144, v232, v233
    v_cvt_pk_bf16_f32 v145, v234, v235
    v_cvt_pk_bf16_f32 v146, v236, v237
    v_cvt_pk_bf16_f32 v147, v238, v239
    v_cvt_pk_bf16_f32 v148, v240, v241
    v_cvt_pk_bf16_f32 v149, v242, v243
    v_cvt_pk_bf16_f32 v150, v244, v245
    v_cvt_pk_bf16_f32 v151, v246, v247
    s_nop 1
    s_branch K3_BACK0
K3_RARE1:
    s_nop 7
    v_mfma_f32_32x32x16_bf16 v[232:247], v[160:163], v[24:27], 0
    v_mfma_f32_32x32x16_bf16 v[232:247], v[164:167], v[28:31], v[232:247]
    s_nop 15
    v_max3_f32 v228, v232, v233, v234
    v_max3_f32 v228, v228, v235, v236
    v_max3_f32 v228, v228, v237, v238
    v_max3_f32 v228, v228, v239, v240
    v_max3_f32 v228, v228, v241, v242
    v_max3_f32 v228, v228, v243, v244
    v_max3_f32 v228, v228, v245, v246
    v_max_f32 v228, v228, v247
    v_mov_b32 v229, v228
    s_nop 1
    v_permlane32_swap_b32 v228, v229
    v_max_f32 v228, v228, v229
    v_add_f32 v228, s49, v228
    v_max_f32 v228, s48, v228
    v_add_f32 v229, v225, v228
    v_cvt_pk_bf16_f32 v230, v229, v229
    v_lshlrev_b32 v230, 16, v230
    v_sub_f32 v229, v229, v230
    v_cvt_pk_bf16_f32 v231, v230, v229
    v_and_b32 v229, 0xffff0000, v231
    v_add_f32 v229, v229, v230
    v_sub_f32 v228, v229, v225
    v_mov_b32 v225, v229
    v_xor_b32 v231, 0x80008000, v231
    v_cndmask_b32 v30, v30, v231, s[44:45]
    v_max_f32 v229, 0, v228
    v_sub_f32 v229, 0, v229
    v_exp_f32 v229, v229
    s_nop 0
    v_mul_f32 v64, v229, v64
    v_mul_f32 v65, v229, v65
    v_mul_f32 v66, v229, v66
    v_mul_f32 v67, v229, v67
    v_mul_f32 v68, v229, v68
    v_mul_f32 v69, v229, v69
    v_mul_f32 v70, v229, v70
    v_mul_f32 v71, v229, v71
    v_mul_f32 v72, v229, v72
    v_mul_f32 v73, v229, v73
    v_mul_f32 v74, v229, v74
    v_mul_f32 v75, v229, v75
    v_mul_f32 v76, v229, v76
    v_mul_f32 v77, v229, v77
    v_mul_f32 v78, v229, v78
    v_mul_f32 v79, v229, v79
    v_sub_f32 v232, v232, v228
    v_sub_f32 v233, v233, v228
    v_sub_f32 v234, v234, v228
    v_sub_f32 v235, v235, v228
    v_sub_f32 v236, v236, v228
    v_sub_f32 v237, v237, v228
    v_sub_f32 v238, v238, v228
    v_sub_f32 v239, v239, v228
    v_sub_f32 v240, v240, v228
    v_sub_f32 v241, v241, v228
    v_sub_f32 v242, v242, v228
    v_sub_f32 v243, v243, v228
    v_sub_f32 v244, v244, v228
    v_sub_f32 v245, v245, v228
    v_sub_f32 v246, v246, v228
    v_sub_f32 v247, v247, v228
    v_exp_f32 v232, v232
    v_exp_f32 v233, v233
    v_exp_f32 v234, v234
    v_exp_f32 v235, v235
    v_exp_f32 v236, v236
    v_exp_f32 v237, v237
    v_exp_f32 v238, v238
    v_exp_f32 v239, v239
    v_exp_f32 v240, v240
    v_exp_f32 v241, v241
    v_exp_f32 v242, v242
    v_exp_f32 v243, v243
    v_exp_f32 v244, v244
    v_exp_f32 v245, v245
    v_exp_f32 v246, v246
    v_exp_f32 v247, v247
    v_cvt_pk_bf16_f32 v152, v232, v233
    v_cvt_pk_bf16_f32 v153, v234, v235
    v_cvt_pk_bf16_f32 v154, v236, v237
    v_cvt_pk_bf16_f32 v155, v238, v239
    v_cvt_pk_bf16_f32 v156, v240, v241
    v_cvt_pk_bf16_f32 v157, v242, v243
    v_cvt_pk_bf16_f32 v158, v244, v245
    v_cvt_pk_bf16_f32 v159, v246, v247
    s_nop 1
    s_branch K3_BACK1
K3_RARE2:
    s_nop 7
    v_mfma_f32_32x32x16_bf16 v[232:247], v[160:163], v[32:35], 0
    v_mfma_f32_32x32x16_bf16 v[232:247], v[164:167], v[36:39], v[232:247]
    s_nop 15
    v_max3_f32 v228, v232, v233, v234
    v_max3_f32 v228, v228, v235, v236
    v_max3_f32 v228, v228, v237, v238
    v_max3_f32 v228, v228, v239, v240
    v_max3_f32 v228, v228, v241, v242
    v_max3_f32 v228, v228, v243, v244
    v_max3_f32 v228, v228, v245, v246
    v_max_f32 v228, v228, v247
    v_mov_b32 v229, v228
    s_nop 1
    v_permlane32_swap_b32 v228, v229
    v_max_f32 v228, v228, v229
    v_add_f32 v228, s49, v228
    v_max_f32 v228, s48, v228
    v_add_f32 v229, v226, v228
    v_cvt_pk_bf16_f32 v230, v229, v229
    v_lshlrev_b32 v230, 16, v230
    v_sub_f32 v229, v229, v230
    v_cvt_pk_bf16_f32 v231, v230, v229
    v_and_b32 v229, 0xffff0000, v231
    v_add_f32 v229, v229, v230
    v_sub_f32 v228, v229, v226
    v_mov_b32 v226, v229
    v_xor_b32 v231, 0x80008000, v231
    v_cndmask_b32 v38, v38, v231, s[44:45]
    v_max_f32 v229, 0, v228
    v_sub_f32 v229, 0, v229
    v_exp_f32 v229, v229
    s_nop 0
    v_mul_f32 v80, v229, v80
    v_mul_f32 v81, v229, v81
    v_mul_f32 v82, v229, v82
    v_mul_f32 v83, v229, v83
    v_mul_f32 v84, v229, v84
    v_mul_f32 v85, v229, v85
    v_mul_f32 v86, v229, v86
    v_mul_f32 v87, v229, v87
    v_mul_f32 v88, v229, v88
    v_mul_f32 v89, v229, v89
    v_mul_f32 v90, v229, v90
    v_mul_f32 v91, v229, v91
    v_mul_f32 v92, v229, v92
    v_mul_f32 v93, v229, v93
    v_mul_f32 v94, v229, v94
    v_mul_f32 v95, v229, v95
    v_sub_f32 v232, v232, v228
    v_sub_f32 v233, v233, v228
    v_sub_f32 v234, v234, v228
    v_sub_f32 v235, v235, v228
    v_sub_f32 v236, v236, v228
    v_sub_f32 v237, v237, v228
    v_sub_f32 v238, v238, v228
    v_sub_f32 v239, v239, v228
    v_sub_f32 v240, v240, v228
    v_sub_f32 v241, v241, v228
    v_sub_f32 v242, v242, v228
    v_sub_f32 v243, v243, v228
    v_sub_f32 v244, v244, v228
    v_sub_f32 v245, v245, v228
    v_sub_f32 v246, v246, v228
    v_sub_f32 v247, v247, v228
    v_exp_f32 v232, v232
    v_exp_f32 v233, v233
    v_exp_f32 v234, v234
    v_exp_f32 v235, v235
    v_exp_f32 v236, v236
    v_exp_f32 v237, v237
    v_exp_f32 v238, v238
    v_exp_f32 v239, v239
    v_exp_f32 v240, v240
    v_exp_f32 v241, v241
    v_exp_f32 v242, v242
    v_exp_f32 v243, v243
    v_exp_f32 v244, v244
    v_exp_f32 v245, v245
    v_exp_f32 v246, v246
    v_exp_f32 v247, v247
    v_cvt_pk_bf16_f32 v144, v232, v233
    v_cvt_pk_bf16_f32 v145, v234, v235
    v_cvt_pk_bf16_f32 v146, v236, v237
    v_cvt_pk_bf16_f32 v147, v238, v239
    v_cvt_pk_bf16_f32 v148, v240, v241
    v_cvt_pk_bf16_f32 v149, v242, v243
    v_cvt_pk_bf16_f32 v150, v244, v245
    v_cvt_pk_bf16_f32 v151, v246, v247
    s_nop 1
    s_branch K3_BACK2
K3_RARE3:
    s_nop 7
    v_mfma_f32_32x32x16_bf16 v[232:247], v[160:163], v[40:43], 0
    v_mfma_f32_32x32x16_bf16 v[232:247], v[164:167], v[44:47], v[232:247]
    s_nop 15
    v_max3_f32 v228, v232, v233, v234
    v_max3_f32 v228, v228, v235, v236
    v_max3_f32 v228, v228, v237, v238
    v_max3_f32 v228, v228, v239, v240
    v_max3_f32 v228, v228, v241, v242
    v_max3_f32 v228, v228, v243, v244
    v_max3_f32 v228, v228, v245, v246
    v_max_f32 v228, v228, v247
    v_mov_b32 v229, v228
    s_nop 1
    v_permlane32_swap_b32 v228, v229
    v_max_f32 v228, v228, v229
    v_add_f32 v228, s49, v228
    v_max_f32 v228, s48, v228
    v_add_f32 v229, v227, v228
    v_cvt_pk_bf16_f32 v230, v229, v229
    v_lshlrev_b32 v230, 16, v230
    v_sub_f32 v229, v229, v230
    v_cvt_pk_bf16_f32 v231, v230, v229
    v_and_b32 v229, 0xffff0000, v231
    v_add_f32 v229, v229, v230
    v_sub_f32 v228, v229, v227
    v_mov_b32 v227, v229
    v_xor_b32 v231, 0x80008000, v231
    v_cndmask_b32 v46, v46, v231, s[44:45]
    v_max_f32 v229, 0, v228
    v_sub_f32 v229, 0, v229
    v_exp_f32 v229, v229
    s_nop 0
    v_mul_f32 v96, v229, v96
    v_mul_f32 v97, v229, v97
    v_mul_f32 v98, v229, v98
    v_mul_f32 v99, v229, v99
    v_mul_f32 v100, v229, v100
    v_mul_f32 v101, v229, v101
    v_mul_f32 v102, v229, v102
    v_mul_f32 v103, v229, v103
    v_mul_f32 v104, v229, v104
    v_mul_f32 v105, v229, v105
    v_mul_f32 v106, v229, v106
    v_mul_f32 v107, v229, v107
    v_mul_f32 v108, v229, v108
    v_mul_f32 v109, v229, v109
    v_mul_f32 v110, v229, v110
    v_mul_f32 v111, v229, v111
    v_sub_f32 v232, v232, v228
    v_sub_f32 v233, v233, v228
    v_sub_f32 v234, v234, v228
    v_sub_f32 v235, v235, v228
    v_sub_f32 v236, v236, v228
    v_sub_f32 v237, v237, v228
    v_sub_f32 v238, v238, v228
    v_sub_f32 v239, v239, v228
    v_sub_f32 v240, v240, v228
    v_sub_f32 v241, v241, v228
    v_sub_f32 v242, v242, v228
    v_sub_f32 v243, v243, v228
    v_sub_f32 v244, v244, v228
    v_sub_f32 v245, v245, v228
    v_sub_f32 v246, v246, v228
    v_sub_f32 v247, v247, v228
    v_exp_f32 v232, v232
    v_exp_f32 v233, v233
    v_exp_f32 v234, v234
    v_exp_f32 v235, v235
    v_exp_f32 v236, v236
    v_exp_f32 v237, v237
    v_exp_f32 v238, v238
    v_exp_f32 v239, v239
    v_exp_f32 v240, v240
    v_exp_f32 v241, v241
    v_exp_f32 v242, v242
    v_exp_f32 v243, v243
    v_exp_f32 v244, v244
    v_exp_f32 v245, v245
    v_exp_f32 v246, v246
    v_exp_f32 v247, v247
    v_cvt_pk_bf16_f32 v152, v232, v233
    v_cvt_pk_bf16_f32 v153, v234, v235
    v_cvt_pk_bf16_f32 v154, v236, v237
    v_cvt_pk_bf16_f32 v155, v238, v239
    v_cvt_pk_bf16_f32 v156, v240, v241
    v_cvt_pk_bf16_f32 v157, v242, v243
    v_cvt_pk_bf16_f32 v158, v244, v245
    v_cvt_pk_bf16_f32 v159, v246, v247
    s_nop 1
    s_branch K3_BACK3
K3_RARE4:
    s_nop 7
    v_mfma_f32_32x32x16_bf16 v[232:247], v[168:171], v[16:19], 0
    v_mfma_f32_32x32x16_bf16 v[232:247], v[172:175], v[20:23], v[232:247]
    s_nop 15
    v_max3_f32 v228, v232, v233, v234
    v_max3_f32 v228, v228, v235, v236
    v_max3_f32 v228, v228, v237, v238
    v_max3_f32 v228, v228, v239, v240
    v_max3_f32 v228, v228, v241, v242
    v_max3_f32 v228, v228, v243, v244
    v_max3_f32 v228, v228, v245, v246
    v_max_f32 v228, v228, v247
    v_mov_b32 v229, v228
    s_nop 1
    v_permlane32_swap_b32 v228, v229
    v_max_f32 v228, v228, v229
    v_add_f32 v228, s49, v228
    v_max_f32 v228, s48, v228
    v_add_f32 v229, v224, v228
    v_cvt_pk_bf16_f32 v230, v229, v229
    v_lshlrev_b32 v230, 16, v230
    v_sub_f32 v229, v229, v230
    v_cvt_pk_bf16_f32 v231, v230, v229
    v_and_b32 v229, 0xffff0000, v231
    v_add_f32 v229, v229, v230
    v_sub_f32 v228, v229, v224
    v_mov_b32 v224, v229
    v_xor_b32 v231, 0x80008000, v231
    v_cndmask_b32 v22, v22, v231, s[44:45]
    v_max_f32 v229, 0, v228
    v_sub_f32 v229, 0, v229
    v_exp_f32 v229, v229
    s_nop 0
    v_mul_f32 v48, v229, v48
    v_mul_f32 v49, v229, v49
    v_mul_f32 v50, v229, v50
    v_mul_f32 v51, v229, v51
    v_mul_f32 v52, v229, v52
    v_mul_f32 v53, v229, v53
    v_mul_f32 v54, v229, v54
    v_mul_f32 v55, v229, v55
    v_mul_f32 v56, v229, v56
    v_mul_f32 v57, v229, v57
    v_mul_f32 v58, v229, v58
    v_mul_f32 v59, v229, v59
    v_mul_f32 v60, v229, v60
    v_mul_f32 v61, v229, v61
    v_mul_f32 v62, v229, v62
    v_mul_f32 v63, v229, v63
    v_sub_f32 v232, v232, v228
    v_sub_f32 v233, v233, v228
    v_sub_f32 v234, v234, v228
    v_sub_f32 v235, v235, v228
    v_sub_f32 v236, v236, v228
    v_sub_f32 v237, v237, v228
    v_sub_f32 v238, v238, v228
    v_sub_f32 v239, v239, v228
    v_sub_f32 v240, v240, v228
    v_sub_f32 v241, v241, v228
    v_sub_f32 v242, v242, v228
    v_sub_f32 v243, v243, v228
    v_sub_f32 v244, v244, v228
    v_sub_f32 v245, v245, v228
    v_sub_f32 v246, v246, v228
    v_sub_f32 v247, v247, v228
    v_exp_f32 v232, v232
    v_exp_f32 v233, v233
    v_exp_f32 v234, v234
    v_exp_f32 v235, v235
    v_exp_f32 v236, v236
    v_exp_f32 v237, v237
    v_exp_f32 v238, v238
    v_exp_f32 v239, v239
    v_exp_f32 v240, v240
    v_exp_f32 v241, v241
    v_exp_f32 v242, v242
    v_exp_f32 v243, v243
    v_exp_f32 v244, v244
    v_exp_f32 v245, v245
    v_exp_f32 v246, v246
    v_exp_f32 v247, v247
    v_cvt_pk_bf16_f32 v144, v232, v233
    v_cvt_pk_bf16_f32 v145, v234, v235
    v_cvt_pk_bf16_f32 v146, v236, v237
    v_cvt_pk_bf16_f32 v147, v238, v239
    v_cvt_pk_bf16_f32 v148, v240, v241
    v_cvt_pk_bf16_f32 v149, v242, v243
    v_cvt_pk_bf16_f32 v150, v244, v245
    v_cvt_pk_bf16_f32 v151, v246, v247
    s_nop 1
    s_branch K3_BACK4
K3_RARE5:
    s_nop 7
    v_mfma_f32_32x32x16_bf16 v[232:247], v[168:171], v[24:27], 0
    v_mfma_f32_32x32x16_bf16 v[232:247], v[172:175], v[28:31], v[232:247]
    s_nop 15
    v_max3_f32 v228, v232, v233, v234
    v_max3_f32 v228, v228, v235, v236
    v_max3_f32 v228, v228, v237, v238
    v_max3_f32 v228, v228, v239, v240
    v_max3_f32 v228, v228, v241, v242
    v_max3_f32 v228, v228, v243, v244
    v_max3_f32 v228, v228, v245, v246
    v_max_f32 v228, v228, v247
    v_mov_b32 v229, v228
    s_nop 1
    v_permlane32_swap_b32 v228, v229
    v_max_f32 v228, v228, v229
    v_add_f32 v228, s49, v228
    v_max_f32 v228, s48, v228
    v_add_f32 v229, v225, v228
    v_cvt_pk_bf16_f32 v230, v229, v229
    v_lshlrev_b32 v230, 16, v230
    v_sub_f32 v229, v229, v230
    v_cvt_pk_bf16_f32 v231, v230, v229
    v_and_b32 v229, 0xffff0000, v231
    v_add_f32 v229, v229, v230
    v_sub_f32 v228, v229, v225
    v_mov_b32 v225, v229
    v_xor_b32 v231, 0x80008000, v231
    v_cndmask_b32 v30, v30, v231, s[44:45]
    v_max_f32 v229, 0, v228
    v_sub_f32 v229, 0, v229
    v_exp_f32 v229, v229
    s_nop 0
    v_mul_f32 v64, v229, v64
    v_mul_f32 v65, v229, v65
    v_mul_f32 v66, v229, v66
    v_mul_f32 v67, v229, v67
    v_mul_f32 v68, v229, v68
    v_mul_f32 v69, v229, v69
    v_mul_f32 v70, v229, v70
    v_mul_f32 v71, v229, v71
    v_mul_f32 v72, v229, v72
    v_mul_f32 v73, v229, v73
    v_mul_f32 v74, v229, v74
    v_mul_f32 v75, v229, v75
    v_mul_f32 v76, v229, v76
    v_mul_f32 v77, v229, v77
    v_mul_f32 v78, v229, v78
    v_mul_f32 v79, v229, v79
    v_sub_f32 v232, v232, v228
    v_sub_f32 v233, v233, v228
    v_sub_f32 v234, v234, v228
    v_sub_f32 v235, v235, v228
    v_sub_f32 v236, v236, v228
    v_sub_f32 v237, v237, v228
    v_sub_f32 v238, v238, v228
    v_sub_f32 v239, v239, v228
    v_sub_f32 v240, v240, v228
    v_sub_f32 v241, v241, v228
    v_sub_f32 v242, v242, v228
    v_sub_f32 v243, v243, v228
    v_sub_f32 v244, v244, v228
    v_sub_f32 v245, v245, v228
    v_sub_f32 v246, v246, v228
    v_sub_f32 v247, v247, v228
    v_exp_f32 v232, v232
    v_exp_f32 v233, v233
    v_exp_f32 v234, v234
    v_exp_f32 v235, v235
    v_exp_f32 v236, v236
    v_exp_f32 v237, v237
    v_exp_f32 v238, v238
    v_exp_f32 v239, v239
    v_exp_f32 v240, v240
    v_exp_f32 v241, v241
    v_exp_f32 v242, v242
    v_exp_f32 v243, v243
    v_exp_f32 v244, v244
    v_exp_f32 v245, v245
    v_exp_f32 v246, v246
    v_exp_f32 v247, v247
    v_cvt_pk_bf16_f32 v152, v232, v233
    v_cvt_pk_bf16_f32 v153, v234, v235
    v_cvt_pk_bf16_f32 v154, v236, v237
    v_cvt_pk_bf16_f32 v155, v238, v239
    v_cvt_pk_bf16_f32 v156, v240, v241
    v_cvt_pk_bf16_f32 v157, v242, v243
    v_cvt_pk_bf16_f32 v158, v244, v245
    v_cvt_pk_bf16_f32 v159, v246, v247
    s_nop 1
    s_branch K3_BACK5
K3_RARE6:
    s_nop 7
    v_mfma_f32_32x32x16_bf16 v[232:247], v[168:171], v[32:35], 0
    v_mfma_f32_32x32x16_bf16 v[232:247], v[172:175], v[36:39], v[232:247]
    s_nop 15
    v_max3_f32 v228, v232, v233, v234
    v_max3_f32 v228, v228, v235, v236
    v_max3_f32 v228, v228, v237, v238
    v_max3_f32 v228, v228, v239, v240
    v_max3_f32 v228, v228, v241, v242
    v_max3_f32 v228, v228, v243, v244
    v_max3_f32 v228, v228, v245, v246
    v_max_f32 v228, v228, v247
    v_mov_b32 v229, v228
    s_nop 1
    v_permlane32_swap_b32 v228, v229
    v_max_f32 v228, v228, v229
    v_add_f32 v228, s49, v228
    v_max_f32 v228, s48, v228
    v_add_f32 v229, v226, v228
    v_cvt_pk_bf16_f32 v230, v229, v229
    v_lshlrev_b32 v230, 16, v230
    v_sub_f32 v229, v229, v230
    v_cvt_pk_bf16_f32 v231, v230, v229
    v_and_b32 v229, 0xffff0000, v231
    v_add_f32 v229, v229, v230
    v_sub_f32 v228, v229, v226
    v_mov_b32 v226, v229
    v_xor_b32 v231, 0x80008000, v231
    v_cndmask_b32 v38, v38, v231, s[44:45]
    v_max_f32 v229, 0, v228
    v_sub_f32 v229, 0, v229
    v_exp_f32 v229, v229
    s_nop 0
    v_mul_f32 v80, v229, v80
    v_mul_f32 v81, v229, v81
    v_mul_f32 v82, v229, v82
    v_mul_f32 v83, v229, v83
    v_mul_f32 v84, v229, v84
    v_mul_f32 v85, v229, v85
    v_mul_f32 v86, v229, v86
    v_mul_f32 v87, v229, v87
    v_mul_f32 v88, v229, v88
    v_mul_f32 v89, v229, v89
    v_mul_f32 v90, v229, v90
    v_mul_f32 v91, v229, v91
    v_mul_f32 v92, v229, v92
    v_mul_f32 v93, v229, v93
    v_mul_f32 v94, v229, v94
    v_mul_f32 v95, v229, v95
    v_sub_f32 v232, v232, v228
    v_sub_f32 v233, v233, v228
    v_sub_f32 v234, v234, v228
    v_sub_f32 v235, v235, v228
    v_sub_f32 v236, v236, v228
    v_sub_f32 v237, v237, v228
    v_sub_f32 v238, v238, v228
    v_sub_f32 v239, v239, v228
    v_sub_f32 v240, v240, v228
    v_sub_f32 v241, v241, v228
    v_sub_f32 v242, v242, v228
    v_sub_f32 v243, v243, v228
    v_sub_f32 v244, v244, v228
    v_sub_f32 v245, v245, v228
    v_sub_f32 v246, v246, v228
    v_sub_f32 v247, v247, v228
    v_exp_f32 v232, v232
    v_exp_f32 v233, v233
    v_exp_f32 v234, v234
    v_exp_f32 v235, v235
    v_exp_f32 v236, v236
    v_exp_f32 v237, v237
    v_exp_f32 v238, v238
    v_exp_f32 v239, v239
    v_exp_f32 v240, v240
    v_exp_f32 v241, v241
    v_exp_f32 v242, v242
    v_exp_f32 v243, v243
    v_exp_f32 v244, v244
    v_exp_f32 v245, v245
    v_exp_f32 v246, v246
    v_exp_f32 v247, v247
    v_cvt_pk_bf16_f32 v144, v232, v233
    v_cvt_pk_bf16_f32 v145, v234, v235
    v_cvt_pk_bf16_f32 v146, v236, v237
    v_cvt_pk_bf16_f32 v147, v238, v239
    v_cvt_pk_bf16_f32 v148, v240, v241
    v_cvt_pk_bf16_f32 v149, v242, v243
    v_cvt_pk_bf16_f32 v150, v244, v245
    v_cvt_pk_bf16_f32 v151, v246, v247
    s_nop 1
    s_branch K3_BACK6
K3_RARE7:
    s_nop 7
    v_mfma_f32_32x32x16_bf16 v[232:247], v[168:171], v[40:43], 0
    v_mfma_f32_32x32x16_bf16 v[232:247], v[172:175], v[44:47], v[232:247]
    s_nop 15
    v_max3_f32 v228, v232, v233, v234
    v_max3_f32 v228, v228, v235, v236
    v_max3_f32 v228, v228, v237, v238
    v_max3_f32 v228, v228, v239, v240
    v_max3_f32 v228, v228, v241, v242
    v_max3_f32 v228, v228, v243, v244
    v_max3_f32 v228, v228, v245, v246
    v_max_f32 v228, v228, v247
    v_mov_b32 v229, v228
    s_nop 1
    v_permlane32_swap_b32 v228, v229
    v_max_f32 v228, v228, v229
    v_add_f32 v228, s49, v228
    v_max_f32 v228, s48, v228
    v_add_f32 v229, v227, v228
    v_cvt_pk_bf16_f32 v230, v229, v229
    v_lshlrev_b32 v230, 16, v230
    v_sub_f32 v229, v229, v230
    v_cvt_pk_bf16_f32 v231, v230, v229
    v_and_b32 v229, 0xffff0000, v231
    v_add_f32 v229, v229, v230
    v_sub_f32 v228, v229, v227
    v_mov_b32 v227, v229
    v_xor_b32 v231, 0x80008000, v231
    v_cndmask_b32 v46, v46, v231, s[44:45]
    v_max_f32 v229, 0, v228
    v_sub_f32 v229, 0, v229
    v_exp_f32 v229, v229
    s_nop 0
    v_mul_f32 v96, v229, v96
    v_mul_f32 v97, v229, v97
    v_mul_f32 v98, v229, v98
    v_mul_f32 v99, v229, v99
    v_mul_f32 v100, v229, v100
    v_mul_f32 v101, v229, v101
    v_mul_f32 v102, v229, v102
    v_mul_f32 v103, v229, v103
    v_mul_f32 v104, v229, v104
    v_mul_f32 v105, v229, v105
    v_mul_f32 v106, v229, v106
    v_mul_f32 v107, v229, v107
    v_mul_f32 v108, v229, v108
    v_mul_f32 v109, v229, v109
    v_mul_f32 v110, v229, v110
    v_mul_f32 v111, v229, v111
    v_sub_f32 v232, v232, v228
    v_sub_f32 v233, v233, v228
    v_sub_f32 v234, v234, v228
    v_sub_f32 v235, v235, v228
    v_sub_f32 v236, v236, v228
    v_sub_f32 v237, v237, v228
    v_sub_f32 v238, v238, v228
    v_sub_f32 v239, v239, v228
    v_sub_f32 v240, v240, v228
    v_sub_f32 v241, v241, v228
    v_sub_f32 v242, v242, v228
    v_sub_f32 v243, v243, v228
    v_sub_f32 v244, v244, v228
    v_sub_f32 v245, v245, v228
    v_sub_f32 v246, v246, v228
    v_sub_f32 v247, v247, v228
    v_exp_f32 v232, v232
    v_exp_f32 v233, v233
    v_exp_f32 v234, v234
    v_exp_f32 v235, v235
    v_exp_f32 v236, v236
    v_exp_f32 v237, v237
    v_exp_f32 v238, v238
    v_exp_f32 v239, v239
    v_exp_f32 v240, v240
    v_exp_f32 v241, v241
    v_exp_f32 v242, v242
    v_exp_f32 v243, v243
    v_exp_f32 v244, v244
    v_exp_f32 v245, v245
    v_exp_f32 v246, v246
    v_exp_f32 v247, v247
    v_cvt_pk_bf16_f32 v152, v232, v233
    v_cvt_pk_bf16_f32 v153, v234, v235
    v_cvt_pk_bf16_f32 v154, v236, v237
    v_cvt_pk_bf16_f32 v155, v238, v239
    v_cvt_pk_bf16_f32 v156, v240, v241
    v_cvt_pk_bf16_f32 v157, v242, v243
    v_cvt_pk_bf16_f32 v158, v244, v245
    v_cvt_pk_bf16_f32 v159, v246, v247
    s_nop 1
    s_branch K3_BACK7
K3_RARE8:
    s_nop 7
    v_mfma_f32_32x32x16_bf16 v[232:247], v[176:179], v[16:19], 0
    v_mfma_f32_32x32x16_bf16 v[232:247], v[180:183], v[20:23], v[232:247]
    s_nop 15
    v_max3_f32 v228, v232, v233, v234
    v_max3_f32 v228, v228, v235, v236
    v_max3_f32 v228, v228, v237, v238
    v_max3_f32 v228, v228, v239, v240
    v_max3_f32 v228, v228, v241, v242
    v_max3_f32 v228, v228, v243, v244
    v_max3_f32 v228, v228, v245, v246
    v_max_f32 v228, v228, v247
    v_mov_b32 v229, v228
    s_nop 1
    v_permlane32_swap_b32 v228, v229
    v_max_f32 v228, v228, v229
    v_add_f32 v228, s49, v228
    v_max_f32 v228, s48, v228
    v_add_f32 v229, v224, v228
    v_cvt_pk_bf16_f32 v230, v229, v229
    v_lshlrev_b32 v230, 16, v230
    v_sub_f32 v229, v229, v230
    v_cvt_pk_bf16_f32 v231, v230, v229
    v_and_b32 v229, 0xffff0000, v231
    v_add_f32 v229, v229, v230
    v_sub_f32 v228, v229, v224
    v_mov_b32 v224, v229
    v_xor_b32 v231, 0x80008000, v231
    v_cndmask_b32 v22, v22, v231, s[44:45]
    v_max_f32 v229, 0, v228
    v_sub_f32 v229, 0, v229
    v_exp_f32 v229, v229
    s_nop 0
    v_mul_f32 v48, v229, v48
    v_mul_f32 v49, v229, v49
    v_mul_f32 v50, v229, v50
    v_mul_f32 v51, v229, v51
    v_mul_f32 v52, v229, v52
    v_mul_f32 v53, v229, v53
    v_mul_f32 v54, v229, v54
    v_mul_f32 v55, v229, v55
    v_mul_f32 v56, v229, v56
    v_mul_f32 v57, v229, v57
    v_mul_f32 v58, v229, v58
    v_mul_f32 v59, v229, v59
    v_mul_f32 v60, v229, v60
    v_mul_f32 v61, v229, v61
    v_mul_f32 v62, v229, v62
    v_mul_f32 v63, v229, v63
    v_sub_f32 v232, v232, v228
    v_sub_f32 v233, v233, v228
    v_sub_f32 v234, v234, v228
    v_sub_f32 v235, v235, v228
    v_sub_f32 v236, v236, v228
    v_sub_f32 v237, v237, v228
    v_sub_f32 v238, v238, v228
    v_sub_f32 v239, v239, v228
    v_sub_f32 v240, v240, v228
    v_sub_f32 v241, v241, v228
    v_sub_f32 v242, v242, v228
    v_sub_f32 v243, v243, v228
    v_sub_f32 v244, v244, v228
    v_sub_f32 v245, v245, v228
    v_sub_f32 v246, v246, v228
    v_sub_f32 v247, v247, v228
    v_exp_f32 v232, v232
    v_exp_f32 v233, v233
    v_exp_f32 v234, v234
    v_exp_f32 v235, v235
    v_exp_f32 v236, v236
    v_exp_f32 v237, v237
    v_exp_f32 v238, v238
    v_exp_f32 v239, v239
    v_exp_f32 v240, v240
    v_exp_f32 v241, v241
    v_exp_f32 v242, v242
    v_exp_f32 v243, v243
    v_exp_f32 v244, v244
    v_exp_f32 v245, v245
    v_exp_f32 v246, v246
    v_exp_f32 v247, v247
    v_cvt_pk_bf16_f32 v144, v232, v233
    v_cvt_pk_bf16_f32 v145, v234, v235
    v_cvt_pk_bf16_f32 v146, v236, v237
    v_cvt_pk_bf16_f32 v147, v238, v239
    v_cvt_pk_bf16_f32 v148, v240, v241
    v_cvt_pk_bf16_f32 v149, v242, v243
    v_cvt_pk_bf16_f32 v150, v244, v245
    v_cvt_pk_bf16_f32 v151, v246, v247
    s_nop 1
    s_branch K3_BACK8
K3_RARE9:
    s_nop 7
    v_mfma_f32_32x32x16_bf16 v[232:247], v[176:179], v[24:27], 0
    v_mfma_f32_32x32x16_bf16 v[232:247], v[180:183], v[28:31], v[232:247]
    s_nop 15
    v_max3_f32 v228, v232, v233, v234
    v_max3_f32 v228, v228, v235, v236
    v_max3_f32 v228, v228, v237, v238
    v_max3_f32 v228, v228, v239, v240
    v_max3_f32 v228, v228, v241, v242
    v_max3_f32 v228, v228, v243, v244
    v_max3_f32 v228, v228, v245, v246
    v_max_f32 v228, v228, v247
    v_mov_b32 v229, v228
    s_nop 1
    v_permlane32_swap_b32 v228, v229
    v_max_f32 v228, v228, v229
    v_add_f32 v228, s49, v228
    v_max_f32 v228, s48, v228
    v_add_f32 v229, v225, v228
    v_cvt_pk_bf16_f32 v230, v229, v229
    v_lshlrev_b32 v230, 16, v230
    v_sub_f32 v229, v229, v230
    v_cvt_pk_bf16_f32 v231, v230, v229
    v_and_b32 v229, 0xffff0000, v231
    v_add_f32 v229, v229, v230
    v_sub_f32 v228, v229, v225
    v_mov_b32 v225, v229
    v_xor_b32 v231, 0x80008000, v231
    v_cndmask_b32 v30, v30, v231, s[44:45]
    v_max_f32 v229, 0, v228
    v_sub_f32 v229, 0, v229
    v_exp_f32 v229, v229
    s_nop 0
    v_mul_f32 v64, v229, v64
    v_mul_f32 v65, v229, v65
    v_mul_f32 v66, v229, v66
    v_mul_f32 v67, v229, v67
    v_mul_f32 v68, v229, v68
    v_mul_f32 v69, v229, v69
    v_mul_f32 v70, v229, v70
    v_mul_f32 v71, v229, v71
    v_mul_f32 v72, v229, v72
    v_mul_f32 v73, v229, v73
    v_mul_f32 v74, v229, v74
    v_mul_f32 v75, v229, v75
    v_mul_f32 v76, v229, v76
    v_mul_f32 v77, v229, v77
    v_mul_f32 v78, v229, v78
    v_mul_f32 v79, v229, v79
    v_sub_f32 v232, v232, v228
    v_sub_f32 v233, v233, v228
    v_sub_f32 v234, v234, v228
    v_sub_f32 v235, v235, v228
    v_sub_f32 v236, v236, v228
    v_sub_f32 v237, v237, v228
    v_sub_f32 v238, v238, v228
    v_sub_f32 v239, v239, v228
    v_sub_f32 v240, v240, v228
    v_sub_f32 v241, v241, v228
    v_sub_f32 v242, v242, v228
    v_sub_f32 v243, v243, v228
    v_sub_f32 v244, v244, v228
    v_sub_f32 v245, v245, v228
    v_sub_f32 v246, v246, v228
    v_sub_f32 v247, v247, v228
    v_exp_f32 v232, v232
    v_exp_f32 v233, v233
    v_exp_f32 v234, v234
    v_exp_f32 v235, v235
    v_exp_f32 v236, v236
    v_exp_f32 v237, v237
    v_exp_f32 v238, v238
    v_exp_f32 v239, v239
    v_exp_f32 v240, v240
    v_exp_f32 v241, v241
    v_exp_f32 v242, v242
    v_exp_f32 v243, v243
    v_exp_f32 v244, v244
    v_exp_f32 v245, v245
    v_exp_f32 v246, v246
    v_exp_f32 v247, v247
    v_cvt_pk_bf16_f32 v152, v232, v233
    v_cvt_pk_bf16_f32 v153, v234, v235
    v_cvt_pk_bf16_f32 v154, v236, v237
    v_cvt_pk_bf16_f32 v155, v238, v239
    v_cvt_pk_bf16_f32 v156, v240, v241
    v_cvt_pk_bf16_f32 v157, v242, v243
    v_cvt_pk_bf16_f32 v158, v244, v245
    v_cvt_pk_bf16_f32 v159, v246, v247
    s_nop 1
    s_branch K3_BACK9
K3_RARE10:
    s_nop 7
    v_mfma_f32_32x32x16_bf16 v[232:247], v[176:179], v[32:35], 0
    v_mfma_f32_32x32x16_bf16 v[232:247], v[180:183], v[36:39], v[232:247]
    s_nop 15
    v_max3_f32 v228, v232, v233, v234
    v_max3_f32 v228, v228, v235, v236
    v_max3_f32 v228, v228, v237, v238
    v_max3_f32 v228, v228, v239, v240
    v_max3_f32 v228, v228, v241, v242
    v_max3_f32 v228, v228, v243, v244
    v_max3_f32 v228, v228, v245, v246
    v_max_f32 v228, v228, v247
    v_mov_b32 v229, v228
    s_nop 1
    v_permlane32_swap_b32 v228, v229
    v_max_f32 v228, v228, v229
    v_add_f32 v228, s49, v228
    v_max_f32 v228, s48, v228
    v_add_f32 v229, v226, v228
    v_cvt_pk_bf16_f32 v230, v229, v229
    v_lshlrev_b32 v230, 16, v230
    v_sub_f32 v229, v229, v230
    v_cvt_pk_bf16_f32 v231, v230, v229
    v_and_b32 v229, 0xffff0000, v231
    v_add_f32 v229, v229, v230
    v_sub_f32 v228, v229, v226
    v_mov_b32 v226, v229
    v_xor_b32 v231, 0x80008000, v231
    v_cndmask_b32 v38, v38, v231, s[44:45]
    v_max_f32 v229, 0, v228
    v_sub_f32 v229, 0, v229
    v_exp_f32 v229, v229
    s_nop 0
    v_mul_f32 v80, v229, v80
    v_mul_f32 v81, v229, v81
    v_mul_f32 v82, v229, v82
    v_mul_f32 v83, v229, v83
    v_mul_f32 v84, v229, v84
    v_mul_f32 v85, v229, v85
    v_mul_f32 v86, v229, v86
    v_mul_f32 v87, v229, v87
    v_mul_f32 v88, v229, v88
    v_mul_f32 v89, v229, v89
    v_mul_f32 v90, v229, v90
    v_mul_f32 v91, v229, v91
    v_mul_f32 v92, v229, v92
    v_mul_f32 v93, v229, v93
    v_mul_f32 v94, v229, v94
    v_mul_f32 v95, v229, v95
    v_sub_f32 v232, v232, v228
    v_sub_f32 v233, v233, v228
    v_sub_f32 v234, v234, v228
    v_sub_f32 v235, v235, v228
    v_sub_f32 v236, v236, v228
    v_sub_f32 v237, v237, v228
    v_sub_f32 v238, v238, v228
    v_sub_f32 v239, v239, v228
    v_sub_f32 v240, v240, v228
    v_sub_f32 v241, v241, v228
    v_sub_f32 v242, v242, v228
    v_sub_f32 v243, v243, v228
    v_sub_f32 v244, v244, v228
    v_sub_f32 v245, v245, v228
    v_sub_f32 v246, v246, v228
    v_sub_f32 v247, v247, v228
    v_exp_f32 v232, v232
    v_exp_f32 v233, v233
    v_exp_f32 v234, v234
    v_exp_f32 v235, v235
    v_exp_f32 v236, v236
    v_exp_f32 v237, v237
    v_exp_f32 v238, v238
    v_exp_f32 v239, v239
    v_exp_f32 v240, v240
    v_exp_f32 v241, v241
    v_exp_f32 v242, v242
    v_exp_f32 v243, v243
    v_exp_f32 v244, v244
    v_exp_f32 v245, v245
    v_exp_f32 v246, v246
    v_exp_f32 v247, v247
    v_cvt_pk_bf16_f32 v144, v232, v233
    v_cvt_pk_bf16_f32 v145, v234, v235
    v_cvt_pk_bf16_f32 v146, v236, v237
    v_cvt_pk_bf16_f32 v147, v238, v239
    v_cvt_pk_bf16_f32 v148, v240, v241
    v_cvt_pk_bf16_f32 v149, v242, v243
    v_cvt_pk_bf16_f32 v150, v244, v245
    v_cvt_pk_bf16_f32 v151, v246, v247
    s_nop 1
    s_branch K3_BACK10
K3_RARE11:
    s_nop 7
    v_mfma_f32_32x32x16_bf16 v[232:247], v[176:179], v[40:43], 0
    v_mfma_f32_32x32x16_bf16 v[232:247], v[180:183], v[44:47], v[232:247]
    s_nop 15
    v_max3_f32 v228, v232, v233, v234
    v_max3_f32 v228, v228, v235, v236
    v_max3_f32 v228, v228, v237, v238
    v_max3_f32 v228, v228, v239, v240
    v_max3_f32 v228, v228, v241, v242
    v_max3_f32 v228, v228, v243, v244
    v_max3_f32 v228, v228, v245, v246
    v_max_f32 v228, v228, v247
    v_mov_b32 v229, v228
    s_nop 1
    v_permlane32_swap_b32 v228, v229
    v_max_f32 v228, v228, v229
    v_add_f32 v228, s49, v228
    v_max_f32 v228, s48, v228
    v_add_f32 v229, v227, v228
    v_cvt_pk_bf16_f32 v230, v229, v229
    v_lshlrev_b32 v230, 16, v230
    v_sub_f32 v229, v229, v230
    v_cvt_pk_bf16_f32 v231, v230, v229
    v_and_b32 v229, 0xffff0000, v231
    v_add_f32 v229, v229, v230
    v_sub_f32 v228, v229, v227
    v_mov_b32 v227, v229
    v_xor_b32 v231, 0x80008000, v231
    v_cndmask_b32 v46, v46, v231, s[44:45]
    v_max_f32 v229, 0, v228
    v_sub_f32 v229, 0, v229
    v_exp_f32 v229, v229
    s_nop 0
    v_mul_f32 v96, v229, v96
    v_mul_f32 v97, v229, v97
    v_mul_f32 v98, v229, v98
    v_mul_f32 v99, v229, v99
    v_mul_f32 v100, v229, v100
    v_mul_f32 v101, v229, v101
    v_mul_f32 v102, v229, v102
    v_mul_f32 v103, v229, v103
    v_mul_f32 v104, v229, v104
    v_mul_f32 v105, v229, v105
    v_mul_f32 v106, v229, v106
    v_mul_f32 v107, v229, v107
    v_mul_f32 v108, v229, v108
    v_mul_f32 v109, v229, v109
    v_mul_f32 v110, v229, v110
    v_mul_f32 v111, v229, v111
    v_sub_f32 v232, v232, v228
    v_sub_f32 v233, v233, v228
    v_sub_f32 v234, v234, v228
    v_sub_f32 v235, v235, v228
    v_sub_f32 v236, v236, v228
    v_sub_f32 v237, v237, v228
    v_sub_f32 v238, v238, v228
    v_sub_f32 v239, v239, v228
    v_sub_f32 v240, v240, v228
    v_sub_f32 v241, v241, v228
    v_sub_f32 v242, v242, v228
    v_sub_f32 v243, v243, v228
    v_sub_f32 v244, v244, v228
    v_sub_f32 v245, v245, v228
    v_sub_f32 v246, v246, v228
    v_sub_f32 v247, v247, v228
    v_exp_f32 v232, v232
    v_exp_f32 v233, v233
    v_exp_f32 v234, v234
    v_exp_f32 v235, v235
    v_exp_f32 v236, v236
    v_exp_f32 v237, v237
    v_exp_f32 v238, v238
    v_exp_f32 v239, v239
    v_exp_f32 v240, v240
    v_exp_f32 v241, v241
    v_exp_f32 v242, v242
    v_exp_f32 v243, v243
    v_exp_f32 v244, v244
    v_exp_f32 v245, v245
    v_exp_f32 v246, v246
    v_exp_f32 v247, v247
    v_cvt_pk_bf16_f32 v152, v232, v233
    v_cvt_pk_bf16_f32 v153, v234, v235
    v_cvt_pk_bf16_f32 v154, v236, v237
    v_cvt_pk_bf16_f32 v155, v238, v239
    v_cvt_pk_bf16_f32 v156, v240, v241
    v_cvt_pk_bf16_f32 v157, v242, v243
    v_cvt_pk_bf16_f32 v158, v244, v245
    v_cvt_pk_bf16_f32 v159, v246, v247
    s_nop 1
    s_branch K3_BACK11
K3_RARE12:
    s_nop 7
    v_mfma_f32_32x32x16_bf16 v[232:247], v[184:187], v[16:19], 0
    v_mfma_f32_32x32x16_bf16 v[232:247], v[188:191], v[20:23], v[232:247]
    s_nop 15
    v_max3_f32 v228, v232, v233, v234
    v_max3_f32 v228, v228, v235, v236
    v_max3_f32 v228, v228, v237, v238
    v_max3_f32 v228, v228, v239, v240
    v_max3_f32 v228, v228, v241, v242
    v_max3_f32 v228, v228, v243, v244
    v_max3_f32 v228, v228, v245, v246
    v_max_f32 v228, v228, v247
    v_mov_b32 v229, v228
    s_nop 1
    v_permlane32_swap_b32 v228, v229
    v_max_f32 v228, v228, v229
    v_add_f32 v228, s49, v228
    v_max_f32 v228, s48, v228
    v_add_f32 v229, v224, v228
    v_cvt_pk_bf16_f32 v230, v229, v229
    v_lshlrev_b32 v230, 16, v230
    v_sub_f32 v229, v229, v230
    v_cvt_pk_bf16_f32 v231, v230, v229
    v_and_b32 v229, 0xffff0000, v231
    v_add_f32 v229, v229, v230
    v_sub_f32 v228, v229, v224
    v_mov_b32 v224, v229
    v_xor_b32 v231, 0x80008000, v231
    v_cndmask_b32 v22, v22, v231, s[44:45]
    v_max_f32 v229, 0, v228
    v_sub_f32 v229, 0, v229
    v_exp_f32 v229, v229
    s_nop 0
    v_mul_f32 v48, v229, v48
    v_mul_f32 v49, v229, v49
    v_mul_f32 v50, v229, v50
    v_mul_f32 v51, v229, v51
    v_mul_f32 v52, v229, v52
    v_mul_f32 v53, v229, v53
    v_mul_f32 v54, v229, v54
    v_mul_f32 v55, v229, v55
    v_mul_f32 v56, v229, v56
    v_mul_f32 v57, v229, v57
    v_mul_f32 v58, v229, v58
    v_mul_f32 v59, v229, v59
    v_mul_f32 v60, v229, v60
    v_mul_f32 v61, v229, v61
    v_mul_f32 v62, v229, v62
    v_mul_f32 v63, v229, v63
    v_sub_f32 v232, v232, v228
    v_sub_f32 v233, v233, v228
    v_sub_f32 v234, v234, v228
    v_sub_f32 v235, v235, v228
    v_sub_f32 v236, v236, v228
    v_sub_f32 v237, v237, v228
    v_sub_f32 v238, v238, v228
    v_sub_f32 v239, v239, v228
    v_sub_f32 v240, v240, v228
    v_sub_f32 v241, v241, v228
    v_sub_f32 v242, v242, v228
    v_sub_f32 v243, v243, v228
    v_sub_f32 v244, v244, v228
    v_sub_f32 v245, v245, v228
    v_sub_f32 v246, v246, v228
    v_sub_f32 v247, v247, v228
    v_exp_f32 v232, v232
    v_exp_f32 v233, v233
    v_exp_f32 v234, v234
    v_exp_f32 v235, v235
    v_exp_f32 v236, v236
    v_exp_f32 v237, v237
    v_exp_f32 v238, v238
    v_exp_f32 v239, v239
    v_exp_f32 v240, v240
    v_exp_f32 v241, v241
    v_exp_f32 v242, v242
    v_exp_f32 v243, v243
    v_exp_f32 v244, v244
    v_exp_f32 v245, v245
    v_exp_f32 v246, v246
    v_exp_f32 v247, v247
    v_cvt_pk_bf16_f32 v144, v232, v233
    v_cvt_pk_bf16_f32 v145, v234, v235
    v_cvt_pk_bf16_f32 v146, v236, v237
    v_cvt_pk_bf16_f32 v147, v238, v239
    v_cvt_pk_bf16_f32 v148, v240, v241
    v_cvt_pk_bf16_f32 v149, v242, v243
    v_cvt_pk_bf16_f32 v150, v244, v245
    v_cvt_pk_bf16_f32 v151, v246, v247
    s_nop 1
    s_branch K3_BACK12
K3_RARE13:
    s_nop 7
    v_mfma_f32_32x32x16_bf16 v[232:247], v[184:187], v[24:27], 0
    v_mfma_f32_32x32x16_bf16 v[232:247], v[188:191], v[28:31], v[232:247]
    s_nop 15
    v_max3_f32 v228, v232, v233, v234
    v_max3_f32 v228, v228, v235, v236
    v_max3_f32 v228, v228, v237, v238
    v_max3_f32 v228, v228, v239, v240
    v_max3_f32 v228, v228, v241, v242
    v_max3_f32 v228, v228, v243, v244
    v_max3_f32 v228, v228, v245, v246
    v_max_f32 v228, v228, v247
    v_mov_b32 v229, v228
    s_nop 1
    v_permlane32_swap_b32 v228, v229
    v_max_f32 v228, v228, v229
    v_add_f32 v228, s49, v228
    v_max_f32 v228, s48, v228
    v_add_f32 v229, v225, v228
    v_cvt_pk_bf16_f32 v230, v229, v229
    v_lshlrev_b32 v230, 16, v230
    v_sub_f32 v229, v229, v230
    v_cvt_pk_bf16_f32 v231, v230, v229
    v_and_b32 v229, 0xffff0000, v231
    v_add_f32 v229, v229, v230
    v_sub_f32 v228, v229, v225
    v_mov_b32 v225, v229
    v_xor_b32 v231, 0x80008000, v231
    v_cndmask_b32 v30, v30, v231, s[44:45]
    v_max_f32 v229, 0, v228
    v_sub_f32 v229, 0, v229
    v_exp_f32 v229, v229
    s_nop 0
    v_mul_f32 v64, v229, v64
    v_mul_f32 v65, v229, v65
    v_mul_f32 v66, v229, v66
    v_mul_f32 v67, v229, v67
    v_mul_f32 v68, v229, v68
    v_mul_f32 v69, v229, v69
    v_mul_f32 v70, v229, v70
    v_mul_f32 v71, v229, v71
    v_mul_f32 v72, v229, v72
    v_mul_f32 v73, v229, v73
    v_mul_f32 v74, v229, v74
    v_mul_f32 v75, v229, v75
    v_mul_f32 v76, v229, v76
    v_mul_f32 v77, v229, v77
    v_mul_f32 v78, v229, v78
    v_mul_f32 v79, v229, v79
    v_sub_f32 v232, v232, v228
    v_sub_f32 v233, v233, v228
    v_sub_f32 v234, v234, v228
    v_sub_f32 v235, v235, v228
    v_sub_f32 v236, v236, v228
    v_sub_f32 v237, v237, v228
    v_sub_f32 v238, v238, v228
    v_sub_f32 v239, v239, v228
    v_sub_f32 v240, v240, v228
    v_sub_f32 v241, v241, v228
    v_sub_f32 v242, v242, v228
    v_sub_f32 v243, v243, v228
    v_sub_f32 v244, v244, v228
    v_sub_f32 v245, v245, v228
    v_sub_f32 v246, v246, v228
    v_sub_f32 v247, v247, v228
    v_exp_f32 v232, v232
    v_exp_f32 v233, v233
    v_exp_f32 v234, v234
    v_exp_f32 v235, v235
    v_exp_f32 v236, v236
    v_exp_f32 v237, v237
    v_exp_f32 v238, v238
    v_exp_f32 v239, v239
    v_exp_f32 v240, v240
    v_exp_f32 v241, v241
    v_exp_f32 v242, v242
    v_exp_f32 v243, v243
    v_exp_f32 v244, v244
    v_exp_f32 v245, v245
    v_exp_f32 v246, v246
    v_exp_f32 v247, v247
    v_cvt_pk_bf16_f32 v152, v232, v233
    v_cvt_pk_bf16_f32 v153, v234, v235
    v_cvt_pk_bf16_f32 v154, v236, v237
    v_cvt_pk_bf16_f32 v155, v238, v239
    v_cvt_pk_bf16_f32 v156, v240, v241
    v_cvt_pk_bf16_f32 v157, v242, v243
    v_cvt_pk_bf16_f32 v158, v244, v245
    v_cvt_pk_bf16_f32 v159, v246, v247
    s_nop 1
    s_branch K3_BACK13
K3_RARE14:
    s_nop 7
    v_mfma_f32_32x32x16_bf16 v[232:247], v[184:187], v[32:35], 0
    v_mfma_f32_32x32x16_bf16 v[232:247], v[188:191], v[36:39], v[232:247]
    s_nop 15
    v_max3_f32 v228, v232, v233, v234
    v_max3_f32 v228, v228, v235, v236
    v_max3_f32 v228, v228, v237, v238
    v_max3_f32 v228, v228, v239, v240
    v_max3_f32 v228, v228, v241, v242
    v_max3_f32 v228, v228, v243, v244
    v_max3_f32 v228, v228, v245, v246
    v_max_f32 v228, v228, v247
    v_mov_b32 v229, v228
    s_nop 1
    v_permlane32_swap_b32 v228, v229
    v_max_f32 v228, v228, v229
    v_add_f32 v228, s49, v228
    v_max_f32 v228, s48, v228
    v_add_f32 v229, v226, v228
    v_cvt_pk_bf16_f32 v230, v229, v229
    v_lshlrev_b32 v230, 16, v230
    v_sub_f32 v229, v229, v230
    v_cvt_pk_bf16_f32 v231, v230, v229
    v_and_b32 v229, 0xffff0000, v231
    v_add_f32 v229, v229, v230
    v_sub_f32 v228, v229, v226
    v_mov_b32 v226, v229
    v_xor_b32 v231, 0x80008000, v231
    v_cndmask_b32 v38, v38, v231, s[44:45]
    v_max_f32 v229, 0, v228
    v_sub_f32 v229, 0, v229
    v_exp_f32 v229, v229
    s_nop 0
    v_mul_f32 v80, v229, v80
    v_mul_f32 v81, v229, v81
    v_mul_f32 v82, v229, v82
    v_mul_f32 v83, v229, v83
    v_mul_f32 v84, v229, v84
    v_mul_f32 v85, v229, v85
    v_mul_f32 v86, v229, v86
    v_mul_f32 v87, v229, v87
    v_mul_f32 v88, v229, v88
    v_mul_f32 v89, v229, v89
    v_mul_f32 v90, v229, v90
    v_mul_f32 v91, v229, v91
    v_mul_f32 v92, v229, v92
    v_mul_f32 v93, v229, v93
    v_mul_f32 v94, v229, v94
    v_mul_f32 v95, v229, v95
    v_sub_f32 v232, v232, v228
    v_sub_f32 v233, v233, v228
    v_sub_f32 v234, v234, v228
    v_sub_f32 v235, v235, v228
    v_sub_f32 v236, v236, v228
    v_sub_f32 v237, v237, v228
    v_sub_f32 v238, v238, v228
    v_sub_f32 v239, v239, v228
    v_sub_f32 v240, v240, v228
    v_sub_f32 v241, v241, v228
    v_sub_f32 v242, v242, v228
    v_sub_f32 v243, v243, v228
    v_sub_f32 v244, v244, v228
    v_sub_f32 v245, v245, v228
    v_sub_f32 v246, v246, v228
    v_sub_f32 v247, v247, v228
    v_exp_f32 v232, v232
    v_exp_f32 v233, v233
    v_exp_f32 v234, v234
    v_exp_f32 v235, v235
    v_exp_f32 v236, v236
    v_exp_f32 v237, v237
    v_exp_f32 v238, v238
    v_exp_f32 v239, v239
    v_exp_f32 v240, v240
    v_exp_f32 v241, v241
    v_exp_f32 v242, v242
    v_exp_f32 v243, v243
    v_exp_f32 v244, v244
    v_exp_f32 v245, v245
    v_exp_f32 v246, v246
    v_exp_f32 v247, v247
    v_cvt_pk_bf16_f32 v144, v232, v233
    v_cvt_pk_bf16_f32 v145, v234, v235
    v_cvt_pk_bf16_f32 v146, v236, v237
    v_cvt_pk_bf16_f32 v147, v238, v239
    v_cvt_pk_bf16_f32 v148, v240, v241
    v_cvt_pk_bf16_f32 v149, v242, v243
    v_cvt_pk_bf16_f32 v150, v244, v245
    v_cvt_pk_bf16_f32 v151, v246, v247
    s_nop 1
    s_branch K3_BACK14
K3_RARE15:
    s_nop 7
    v_mfma_f32_32x32x16_bf16 v[232:247], v[184:187], v[40:43], 0
    v_mfma_f32_32x32x16_bf16 v[232:247], v[188:191], v[44:47], v[232:247]
    s_nop 15
    v_max3_f32 v228, v232, v233, v234
    v_max3_f32 v228, v228, v235, v236
    v_max3_f32 v228, v228, v237, v238
    v_max3_f32 v228, v228, v239, v240
    v_max3_f32 v228, v228, v241, v242
    v_max3_f32 v228, v228, v243, v244
    v_max3_f32 v228, v228, v245, v246
    v_max_f32 v228, v228, v247
    v_mov_b32 v229, v228
    s_nop 1
    v_permlane32_swap_b32 v228, v229
    v_max_f32 v228, v228, v229
    v_add_f32 v228, s49, v228
    v_max_f32 v228, s48, v228
    v_add_f32 v229, v227, v228
    v_cvt_pk_bf16_f32 v230, v229, v229
    v_lshlrev_b32 v230, 16, v230
    v_sub_f32 v229, v229, v230
    v_cvt_pk_bf16_f32 v231, v230, v229
    v_and_b32 v229, 0xffff0000, v231
    v_add_f32 v229, v229, v230
    v_sub_f32 v228, v229, v227
    v_mov_b32 v227, v229
    v_xor_b32 v231, 0x80008000, v231
    v_cndmask_b32 v46, v46, v231, s[44:45]
    v_max_f32 v229, 0, v228
    v_sub_f32 v229, 0, v229
    v_exp_f32 v229, v229
    s_nop 0
    v_mul_f32 v96, v229, v96
    v_mul_f32 v97, v229, v97
    v_mul_f32 v98, v229, v98
    v_mul_f32 v99, v229, v99
    v_mul_f32 v100, v229, v100
    v_mul_f32 v101, v229, v101
    v_mul_f32 v102, v229, v102
    v_mul_f32 v103, v229, v103
    v_mul_f32 v104, v229, v104
    v_mul_f32 v105, v229, v105
    v_mul_f32 v106, v229, v106
    v_mul_f32 v107, v229, v107
    v_mul_f32 v108, v229, v108
    v_mul_f32 v109, v229, v109
    v_mul_f32 v110, v229, v110
    v_mul_f32 v111, v229, v111
    v_sub_f32 v232, v232, v228
    v_sub_f32 v233, v233, v228
    v_sub_f32 v234, v234, v228
    v_sub_f32 v235, v235, v228
    v_sub_f32 v236, v236, v228
    v_sub_f32 v237, v237, v228
    v_sub_f32 v238, v238, v228
    v_sub_f32 v239, v239, v228
    v_sub_f32 v240, v240, v228
    v_sub_f32 v241, v241, v228
    v_sub_f32 v242, v242, v228
    v_sub_f32 v243, v243, v228
    v_sub_f32 v244, v244, v228
    v_sub_f32 v245, v245, v228
    v_sub_f32 v246, v246, v228
    v_sub_f32 v247, v247, v228
    v_exp_f32 v232, v232
    v_exp_f32 v233, v233
    v_exp_f32 v234, v234
    v_exp_f32 v235, v235
    v_exp_f32 v236, v236
    v_exp_f32 v237, v237
    v_exp_f32 v238, v238
    v_exp_f32 v239, v239
    v_exp_f32 v240, v240
    v_exp_f32 v241, v241
    v_exp_f32 v242, v242
    v_exp_f32 v243, v243
    v_exp_f32 v244, v244
    v_exp_f32 v245, v245
    v_exp_f32 v246, v246
    v_exp_f32 v247, v247
    v_cvt_pk_bf16_f32 v152, v232, v233
    v_cvt_pk_bf16_f32 v153, v234, v235
    v_cvt_pk_bf16_f32 v154, v236, v237
    v_cvt_pk_bf16_f32 v155, v238, v239
    v_cvt_pk_bf16_f32 v156, v240, v241
    v_cvt_pk_bf16_f32 v157, v242, v243
    v_cvt_pk_bf16_f32 v158, v244, v245
    v_cvt_pk_bf16_f32 v159, v246, v247
    s_nop 1
    s_branch K3_BACK15
K3_RARE16:
    s_nop 7
    v_mfma_f32_32x32x16_bf16 v[232:247], v[184:187], v[40:43], 0
    v_mfma_f32_32x32x16_bf16 v[232:247], v[188:191], v[44:47], v[232:247]
    s_nop 15
    v_max3_f32 v228, v232, v233, v234
    v_max3_f32 v228, v228, v235, v236
    v_max3_f32 v228, v228, v237, v238
    v_max3_f32 v228, v228, v239, v240
    v_max3_f32 v228, v228, v241, v242
    v_max3_f32 v228, v228, v243, v244
    v_max3_f32 v228, v228, v245, v246
    v_max_f32 v228, v228, v247
    v_mov_b32 v229, v228
    s_nop 1
    v_permlane32_swap_b32 v228, v229
    v_max_f32 v228, v228, v229
    v_add_f32 v228, s49, v228
    v_max_f32 v228, s48, v228
    v_add_f32 v229, v227, v228
    v_cvt_pk_bf16_f32 v230, v229, v229
    v_lshlrev_b32 v230, 16, v230
    v_sub_f32 v229, v229, v230
    v_cvt_pk_bf16_f32 v231, v230, v229
    v_and_b32 v229, 0xffff0000, v231
    v_add_f32 v229, v229, v230
    v_sub_f32 v228, v229, v227
    v_mov_b32 v227, v229
    v_xor_b32 v231, 0x80008000, v231
    v_cndmask_b32 v46, v46, v231, s[44:45]
    v_max_f32 v229, 0, v228
    v_sub_f32 v229, 0, v229
    v_exp_f32 v229, v229
    s_nop 0
    v_mul_f32 v96, v229, v96
    v_mul_f32 v97, v229, v97
    v_mul_f32 v98, v229, v98
    v_mul_f32 v99, v229, v99
    v_mul_f32 v100, v229, v100
    v_mul_f32 v101, v229, v101
    v_mul_f32 v102, v229, v102
    v_mul_f32 v103, v229, v103
    v_mul_f32 v104, v229, v104
    v_mul_f32 v105, v229, v105
    v_mul_f32 v106, v229, v106
    v_mul_f32 v107, v229, v107
    v_mul_f32 v108, v229, v108
    v_mul_f32 v109, v229, v109
    v_mul_f32 v110, v229, v110
    v_mul_f32 v111, v229, v111
    v_sub_f32 v232, v232, v228
    v_sub_f32 v233, v233, v228
    v_sub_f32 v234, v234, v228
    v_sub_f32 v235, v235, v228
    v_sub_f32 v236, v236, v228
    v_sub_f32 v237, v237, v228
    v_sub_f32 v238, v238, v228
    v_sub_f32 v239, v239, v228
    v_sub_f32 v240, v240, v228
    v_sub_f32 v241, v241, v228
    v_sub_f32 v242, v242, v228
    v_sub_f32 v243, v243, v228
    v_sub_f32 v244, v244, v228
    v_sub_f32 v245, v245, v228
    v_sub_f32 v246, v246, v228
    v_sub_f32 v247, v247, v228
    v_exp_f32 v232, v232
    v_exp_f32 v233, v233
    v_exp_f32 v234, v234
    v_exp_f32 v235, v235
    v_exp_f32 v236, v236
    v_exp_f32 v237, v237
    v_exp_f32 v238, v238
    v_exp_f32 v239, v239
    v_exp_f32 v240, v240
    v_exp_f32 v241, v241
    v_exp_f32 v242, v242
    v_exp_f32 v243, v243
    v_exp_f32 v244, v244
    v_exp_f32 v245, v245
    v_exp_f32 v246, v246
    v_exp_f32 v247, v247
    v_cvt_pk_bf16_f32 v152, v232, v233
    v_cvt_pk_bf16_f32 v153, v234, v235
    v_cvt_pk_bf16_f32 v154, v236, v237
    v_cvt_pk_bf16_f32 v155, v238, v239
    v_cvt_pk_bf16_f32 v156, v240, v241
    v_cvt_pk_bf16_f32 v157, v242, v243
    v_cvt_pk_bf16_f32 v158, v244, v245
    v_cvt_pk_bf16_f32 v159, v246, v247
    s_nop 1
    s_branch K3_BACK16
K3_END:
    s_endpgm
.globl ffn1_kernel
.p2align 8
.type ffn1_kernel,@function
ffn1_kernel:
    s_cmp_ge_u32 s2, 224
    s_cbranch_scc1 K5_END
    s_load_dwordx2 s[34:35], s[0:1], 80
    s_waitcnt lgkmcnt(0)
    s_mov_b32 s36, s34
    s_mov_b32 s37, s35
    s_mov_b32 s38, 0x1b00000
    s_mov_b32 s39, 0x00020000
    v_lshrrev_b32 v8, 6, v0
    s_nop 0
    v_readfirstlane_b32 s6, v8
    v_and_b32 v1, 63, v0
    v_and_b32 v2, 31, v0
    v_bfe_u32 v3, v0, 5, 1
    v_lshlrev_b32 v4, 4, v1
    s_and_b32 s7, s2, 7
    s_lshr_b32 s8, s2, 3
    s_and_b32 s3, s7, 3
    s_lshl_b32 s3, s3, 2
    s_and_b32 s9, s8, 3
    s_add_u32 s3, s3, s9
    s_lshr_b32 s4, s7, 2
    s_mul_i32 s4, s4, 7
    s_lshr_b32 s9, s8, 2
    s_add_u32 s4, s4, s9
    s_lshl_b32 s5, s4, 2
    s_add_u32 s5, s5, s6
    v_lshlrev_b32 v9, 3, v0
    v_cmp_gt_u32 vcc, 128, v0
    v_lshlrev_b32 v13, 7, v0
    s_lshl_b32 s10, s3, 14
    s_add_u32 s10, s10, 0x80000
    s_cmp_ge_u32 s6, 2
    s_cbranch_scc1 K5_NOST
    buffer_load_dwordx4 v[196:199], v13, s[36:39], s10 offen offset:0
    buffer_load_dwordx4 v[200:203], v13, s[36:39], s10 offen offset:16
    buffer_load_dwordx4 v[204:207], v13, s[36:39], s10 offen offset:32
    buffer_load_dwordx4 v[208:211], v13, s[36:39], s10 offen offset:48
    buffer_load_dwordx4 v[212:215], v13, s[36:39], s10 offen offset:64
    buffer_load_dwordx4 v[216:219], v13, s[36:39], s10 offen offset:80
    buffer_load_dwordx4 v[220:223], v13, s[36:39], s10 offen offset:96
K5_NOST:
    v_lshlrev_b32 v10, 2, v0
    v_lshlrev_b32 v13, 6, v0
    s_lshl_b32 s10, s4, 14
    s_add_u32 s10, s10, 0x40000
    buffer_load_dwordx4 v[228:231], v13, s[36:39], s10 offen offset:0
    buffer_load_dwordx4 v[232:235], v13, s[36:39], s10 offen offset:16
    buffer_load_dwordx4 v[236:239], v13, s[36:39], s10 offen offset:32
    buffer_load_dwordx2 v[240:241], v13, s[36:39], s10 offen offset:48
    s_mul_i32 s12, s3, 114688
    s_add_u32 s12, s12, 0xf00000
    s_lshl_b32 s11, s6, 10
    s_add_u32 s15, s12, s11
    s_add_u32 s16, s11, 2048
    s_mul_i32 s11, s6, 7168
    s_add_u32 s12, s12, s11
    s_add_u32 s12, s12, 28672
    s_add_u32 s11, s11, 30720
    s_mul_i32 s8, s5, 28672
    s_add_u32 s8, s8, 0x300000
    s_mov_b32 m0, s16
    s_nop 0
    buffer_load_dwordx4 v4, s[36:39], s15 offen lds
    buffer_load_dwordx4 v[16:19], v4, s[36:39], s8 offen offset:0
    buffer_load_dwordx4 v[20:23], v4, s[36:39], s8 offen offset:1024
    buffer_load_dwordx4 v[24:27], v4, s[36:39], s8 offen offset:2048
    buffer_load_dwordx4 v[28:31], v4, s[36:39], s8 offen offset:3072
    s_add_u32 s15, s15, 4096
    s_add_u32 s16, s16, 4096
    s_add_u32 s8, s8, 4096
    s_mov_b32 m0, s16
    s_nop 0
    buffer_load_dwordx4 v4, s[36:39], s15 offen lds
    buffer_load_dwordx4 v[32:35], v4, s[36:39], s8 offen offset:0
    buffer_load_dwordx4 v[36:39], v4, s[36:39], s8 offen offset:1024
    buffer_load_dwordx4 v[40:43], v4, s[36:39], s8 offen offset:2048
    buffer_load_dwordx4 v[44:47], v4, s[36:39], s8 offen offset:3072
    s_add_u32 s15, s15, 4096
    s_add_u32 s16, s16, 4096
    s_add_u32 s8, s8, 4096
    s_mov_b32 m0, s16
    s_nop 0
    buffer_load_dwordx4 v4, s[36:39], s15 offen lds
    buffer_load_dwordx4 v[48:51], v4, s[36:39], s8 offen offset:0
    buffer_load_dwordx4 v[52:55], v4, s[36:39], s8 offen offset:1024
    buffer_load_dwordx4 v[56:59], v4, s[36:39], s8 offen offset:2048
    buffer_load_dwordx4 v[60:63], v4, s[36:39], s8 offen offset:3072
    s_add_u32 s15, s15, 4096
    s_add_u32 s16, s16, 4096
    s_add_u32 s8, s8, 4096
    s_mov_b32 m0, s16
    s_nop 0
    buffer_load_dwordx4 v4, s[36:39], s15 offen lds
    buffer_load_dwordx4 v[64:67], v4, s[36:39], s8 offen offset:0
    buffer_load_dwordx4 v[68:71], v4, s[36:39], s8 offen offset:1024
    buffer_load_dwordx4 v[72:75], v4, s[36:39], s8 offen offset:2048
    buffer_load_dwordx4 v[76:79], v4, s[36:39], s8 offen offset:3072
    s_add_u32 s15, s15, 4096
    s_add_u32 s16, s16, 4096
    s_add_u32 s8, s8, 4096
    s_waitcnt vmcnt(20)
    s_mov_b32 s14, 0xbfb8aa3b
    v_add_f32 v228, v228, v229
    v_add_f32 v228, v228, v230
    v_add_f32 v228, v228, v231
    v_add_f32 v228, v228, v232
    v_add_f32 v228, v228, v233
    v_add_f32 v228, v228, v234
    v_add_f32 v228, v228, v235
    v_add_f32 v228, v228, v236
    v_add_f32 v228, v228, v237
    v_add_f32 v228, v228, v238
    v_add_f32 v228, v228, v239
    v_add_f32 v228, v228, v240
    v_add_f32 v228, v228, v241
    v_mul_f32 v228, s14, v228
    ds_write_b32 v10, v228
    v_add_f32 v196, v196, v198
    v_add_f32 v197, v197, v199
    v_add_f32 v196, v196, v200
    v_add_f32 v197, v197, v201
    v_add_f32 v196, v196, v202
    v_add_f32 v197, v197, v203
    v_add_f32 v196, v196, v204
    v_add_f32 v197, v197, v205
    v_add_f32 v196, v196, v206
    v_add_f32 v197, v197, v207
    v_add_f32 v196, v196, v208
    v_add_f32 v197, v197, v209
    v_add_f32 v196, v196, v210
    v_add_f32 v197, v197, v211
    v_add_f32 v196, v196, v212
    v_add_f32 v197, v197, v213
    v_add_f32 v196, v196, v214
    v_add_f32 v197, v197, v215
    v_add_f32 v196, v196, v216
    v_add_f32 v197, v197, v217
    v_add_f32 v196, v196, v218
    v_add_f32 v197, v197, v219
    v_add_f32 v196, v196, v220
    v_add_f32 v197, v197, v221
    v_add_f32 v196, v196, v222
    v_add_f32 v197, v197, v223
    s_mov_b32 s9, 0x3b124925
    v_mul_f32 v196, s9, v196
    v_mul_f32 v197, s9, v197
    v_fma_f32 v197, -v196, v196, v197
    v_max_f32 v197, 0, v197
    v_add_f32 v197, 0x3727c5ac, v197
    v_rsq_f32 v198, v197
    s_nop 0
    v_mul_f32 v199, v198, v196
    v_sub_f32 v199, 0, v199
    v_mul_f32 v198, s14, v198
    s_and_saveexec_b64 s[44:45], vcc
    ds_write_b64 v9, v[198:199] offset:1024
    s_mov_b64 exec, s[44:45]
    v_add_u32 v11, 0xe000, v4
    v_lshlrev_b32 v12, 4, v3
    s_lshl_b32 s10, s6, 8
    v_add_u32 v12, s10, v12
    v_lshlrev_b32 v13, 3, v2
    s_mov_b32 s14, 0xbfb8aa3b
    s_lshl_b32 s13, s3, 2
    s_mul_i32 s13, s13, 56
    s_add_u32 s13, s13, s5
    s_lshl_b32 s13, s13, 11
    s_add_u32 s13, s13, 0x1100000
    s_waitcnt vmcnt(10) lgkmcnt(0)
    s_barrier
    ds_read_b128 v[200:203], v12 offset:0
    ds_read_b128 v[204:207], v12 offset:32
    ds_read_b128 v[208:211], v12 offset:64
    ds_read_b128 v[212:215], v12 offset:96
    ds_read_b128 v[216:219], v12 offset:128
    ds_read_b128 v[220:223], v12 offset:160
    ds_read_b128 v[224:227], v12 offset:192
    ds_read_b128 v[228:231], v12 offset:224
    ds_read_b64 v[232:233], v13 offset:1024
    ds_read_b64 v[234:235], v13 offset:1280
    ds_read_b64 v[236:237], v13 offset:1536
    ds_read_b64 v[238:239], v13 offset:1792
    ds_read_b128 v[160:163], v4 offset:2048
    ds_read_b128 v[164:167], v4 offset:3072
    ds_read_b128 v[168:171], v4 offset:4096
    ds_read_b128 v[172:175], v4 offset:5120
    s_mov_b32 m0, s16
    s_nop 0
    buffer_load_dwordx4 v4, s[36:39], s15 offen lds
    buffer_load_dwordx4 v[80:83], v4, s[36:39], s8 offen offset:0
    buffer_load_dwordx4 v[84:87], v4, s[36:39], s8 offen offset:1024
    buffer_load_dwordx4 v[88:91], v4, s[36:39], s8 offen offset:2048
    buffer_load_dwordx4 v[92:95], v4, s[36:39], s8 offen offset:3072
    s_add_u32 s15, s15, 4096
    s_add_u32 s16, s16, 4096
    s_add_u32 s8, s8, 4096
    ds_read_b128 v[176:179], v4 offset:6144
    s_waitcnt lgkmcnt(4)
    v_mfma_f32_32x32x16_bf16 v[128:143], v[16:19], v[160:163], 0
    ds_read_b128 v[180:183], v4 offset:7168
    s_waitcnt lgkmcnt(4)
    v_mfma_f32_32x32x16_bf16 v[128:143], v[20:23], v[164:167], v[128:143]
    ds_read_b128 v[160:163], v4 offset:8192
    s_waitcnt lgkmcnt(4)
    v_mfma_f32_32x32x16_bf16 v[128:143], v[24:27], v[168:171], v[128:143]
    s_waitcnt vmcnt(10)
    s_barrier
    ds_read_b128 v[164:167], v4 offset:9216
    s_waitcnt lgkmcnt(4)
    v_mfma_f32_32x32x16_bf16 v[128:143], v[28:31], v[172:175], v[128:143]
    s_mov_b32 m0, s16
    s_nop 0
    buffer_load_dwordx4 v4, s[36:39], s15 offen lds
    buffer_load_dwordx4 v[96:99], v4, s[36:39], s8 offen offset:0
    buffer_load_dwordx4 v[100:103], v4, s[36:39], s8 offen offset:1024
    buffer_load_dwordx4 v[104:107], v4, s[36:39], s8 offen offset:2048
    buffer_load_dwordx4 v[108:111], v4, s[36:39], s8 offen offset:3072
    s_add_u32 s15, s15, 4096
    s_add_u32 s16, s16, 4096
    s_add_u32 s8, s8, 4096
    ds_read_b128 v[168:171], v4 offset:10240
    s_waitcnt lgkmcnt(4)
    v_mfma_f32_32x32x16_bf16 v[128:143], v[32:35], v[176:179], v[128:143]
    ds_read_b128 v[172:175], v4 offset:11264
    s_waitcnt lgkmcnt(4)
    v_mfma_f32_32x32x16_bf16 v[128:143], v[36:39], v[180:183], v[128:143]
    ds_read_b128 v[176:179], v4 offset:12288
    s_waitcnt lgkmcnt(4)
    v_mfma_f32_32x32x16_bf16 v[128:143], v[40:43], v[160:163], v[128:143]
    s_waitcnt vmcnt(10)
    s_barrier
    ds_read_b128 v[180:183], v4 offset:13312
    s_waitcnt lgkmcnt(4)
    v_mfma_f32_32x32x16_bf16 v[128:143], v[44:47], v[164:167], v[128:143]
    s_mov_b32 m0, s16
    s_nop 0
    buffer_load_dwordx4 v4, s[36:39], s15 offen lds
    buffer_load_dwordx4 v[112:115], v4, s[36:39], s8 offen offset:0
    buffer_load_dwordx4 v[116:119], v4, s[36:39], s8 offen offset:1024
    buffer_load_dwordx4 v[120:123], v4, s[36:39], s8 offen offset:2048
    buffer_load_dwordx4 v[124:127], v4, s[36:39], s8 offen offset:3072
    s_add_u32 s15, s15, 4096
    s_add_u32 s16, s16, 4096
    s_add_u32 s8, s8, 4096
    ds_read_b128 v[160:163], v4 offset:14336
    s_waitcnt lgkmcnt(4)
    v_mfma_f32_32x32x16_bf16 v[128:143], v[48:51], v[168:171], v[128:143]
    ds_read_b128 v[164:167], v4 offset:15360
    s_waitcnt lgkmcnt(4)
    v_mfma_f32_32x32x16_bf16 v[128:143], v[52:55], v[172:175], v[128:143]
    ds_read_b128 v[168:171], v4 offset:16384
    s_waitcnt lgkmcnt(4)
    v_mfma_f32_32x32x16_bf16 v[128:143], v[56:59], v[176:179], v[128:143]
    s_waitcnt vmcnt(10)
    s_barrier
    ds_read_b128 v[172:175], v4 offset:17408
    s_waitcnt lgkmcnt(4)
    v_mfma_f32_32x32x16_bf16 v[128:143], v[60:63], v[180:183], v[128:143]
    s_mov_b32 m0, s11
    s_nop 0
    buffer_load_dwordx4 v4, s[36:39], s12 offen lds
    s_add_u32 s11, s11, 1024
    s_add_u32 s12, s12, 1024
    s_mov_b32 m0, s11
    s_nop 0
    buffer_load_dwordx4 v4, s[36:39], s12 offen lds
    s_add_u32 s11, s11, 1024
    s_add_u32 s12, s12, 1024
    s_mov_b32 m0, s11
    s_nop 0
    buffer_load_dwordx4 v4, s[36:39], s12 offen lds
    s_add_u32 s11, s11, 1024
    s_add_u32 s12, s12, 1024
    s_mov_b32 m0, s11
    s_nop 0
    buffer_load_dwordx4 v4, s[36:39], s12 offen lds
    s_add_u32 s11, s11, 1024
    s_add_u32 s12, s12, 1024
    s_mov_b32 m0, s11
    s_nop 0
    buffer_load_dwordx4 v4, s[36:39], s12 offen lds
    s_add_u32 s11, s11, 1024
    s_add_u32 s12, s12, 1024
    s_mov_b32 m0, s11
    s_nop 0
    buffer_load_dwordx4 v4, s[36:39], s12 offen lds
    s_add_u32 s11, s11, 1024
    s_add_u32 s12, s12, 1024
    s_mov_b32 m0, s11
    s_nop 0
    buffer_load_dwordx4 v4, s[36:39], s12 offen lds
    s_add_u32 s11, s11, 22528
    s_add_u32 s12, s12, 22528
    ds_read_b128 v[176:179], v4 offset:18432
    s_waitcnt lgkmcnt(4)
    v_mfma_f32_32x32x16_bf16 v[128:143], v[64:67], v[160:163], v[128:143]
    ds_read_b128 v[180:183], v4 offset:19456
    s_waitcnt lgkmcnt(4)
    v_mfma_f32_32x32x16_bf16 v[128:143], v[68:71], v[164:167], v[128:143]
    ds_read_b128 v[160:163], v4 offset:20480
    s_waitcnt lgkmcnt(4)
    v_mfma_f32_32x32x16_bf16 v[128:143], v[72:75], v[168:171], v[128:143]
    s_waitcnt vmcnt(12)
    s_barrier
    ds_read_b128 v[164:167], v4 offset:21504
    s_waitcnt lgkmcnt(4)
    v_mfma_f32_32x32x16_bf16 v[128:143], v[76:79], v[172:175], v[128:143]
    s_mov_b32 m0, s11
    s_nop 0
    buffer_load_dwordx4 v4, s[36:39], s12 offen lds
    s_add_u32 s11, s11, 1024
    s_add_u32 s12, s12, 1024
    s_mov_b32 m0, s11
    s_nop 0
    buffer_load_dwordx4 v4, s[36:39], s12 offen lds
    s_add_u32 s11, s11, 1024
    s_add_u32 s12, s12, 1024
    s_mov_b32 m0, s11
    s_nop 0
    buffer_load_dwordx4 v4, s[36:39], s12 offen lds
    s_add_u32 s11, s11, 1024
    s_add_u32 s12, s12, 1024
    s_mov_b32 m0, s11
    s_nop 0
    buffer_load_dwordx4 v4, s[36:39], s12 offen lds
    s_add_u32 s11, s11, 1024
    s_add_u32 s12, s12, 1024
    s_mov_b32 m0, s11
    s_nop 0
    buffer_load_dwordx4 v4, s[36:39], s12 offen lds
    s_add_u32 s11, s11, 1024
    s_add_u32 s12, s12, 1024
    s_mov_b32 m0, s11
    s_nop 0
    buffer_load_dwordx4 v4, s[36:39], s12 offen lds
    s_add_u32 s11, s11, 1024
    s_add_u32 s12, s12, 1024
    s_mov_b32 m0, s11
    s_nop 0
    buffer_load_dwordx4 v4, s[36:39], s12 offen lds
    s_add_u32 s11, s11, 22528
    s_add_u32 s12, s12, 22528
    ds_read_b128 v[168:171], v4 offset:22528
    s_waitcnt lgkmcnt(4)
    v_mfma_f32_32x32x16_bf16 v[128:143], v[80:83], v[176:179], v[128:143]
    ds_read_b128 v[172:175], v4 offset:23552
    s_waitcnt lgkmcnt(4)
    v_mfma_f32_32x32x16_bf16 v[128:143], v[84:87], v[180:183], v[128:143]
    ds_read_b128 v[176:179], v4 offset:24576
    s_waitcnt lgkmcnt(4)
    v_mfma_f32_32x32x16_bf16 v[128:143], v[88:91], v[160:163], v[128:143]
    s_waitcnt vmcnt(14)
    s_barrier
    ds_read_b128 v[180:183], v4 offset:25600
    s_waitcnt lgkmcnt(4)
    v_mfma_f32_32x32x16_bf16 v[128:143], v[92:95], v[164:167], v[128:143]
    s_mov_b32 m0, s11
    s_nop 0
    buffer_load_dwordx4 v4, s[36:39], s12 offen lds
    s_add_u32 s11, s11, 1024
    s_add_u32 s12, s12, 1024
    s_mov_b32 m0, s11
    s_nop 0
    buffer_load_dwordx4 v4, s[36:39], s12 offen lds
    s_add_u32 s11, s11, 1024
    s_add_u32 s12, s12, 1024
    s_mov_b32 m0, s11
    s_nop 0
    buffer_load_dwordx4 v4, s[36:39], s12 offen lds
    s_add_u32 s11, s11, 1024
    s_add_u32 s12, s12, 1024
    s_mov_b32 m0, s11
    s_nop 0
    buffer_load_dwordx4 v4, s[36:39], s12 offen lds
    s_add_u32 s11, s11, 1024
    s_add_u32 s12, s12, 1024
    s_mov_b32 m0, s11
    s_nop 0
    buffer_load_dwordx4 v4, s[36:39], s12 offen lds
    s_add_u32 s11, s11, 1024
    s_add_u32 s12, s12, 1024
    s_mov_b32 m0, s11
    s_nop 0
    buffer_load_dwordx4 v4, s[36:39], s12 offen lds
    s_add_u32 s11, s11, 1024
    s_add_u32 s12, s12, 1024
    s_mov_b32 m0, s11
    s_nop 0
    buffer_load_dwordx4 v4, s[36:39], s12 offen lds
    s_waitcnt vmcnt(14)
    s_barrier
    ds_read_b128 v[160:163], v4 offset:26624
    s_waitcnt lgkmcnt(4)
    v_mfma_f32_32x32x16_bf16 v[128:143], v[96:99], v[168:171], v[128:143]
    ds_read_b128 v[164:167], v4 offset:27648
    s_waitcnt lgkmcnt(4)
    v_mfma_f32_32x32x16_bf16 v[128:143], v[100:103], v[172:175], v[128:143]
    ds_read_b128 v[168:171], v4 offset:28672
    s_waitcnt lgkmcnt(4)
    v_mfma_f32_32x32x16_bf16 v[128:143], v[104:107], v[176:179], v[128:143]
    ds_read_b128 v[172:175], v4 offset:29696
    s_waitcnt lgkmcnt(4)
    v_mfma_f32_32x32x16_bf16 v[128:143], v[108:111], v[180:183], v[128:143]
    ds_read_b128 v[176:179], v4 offset:30720
    s_waitcnt lgkmcnt(4)
    v_mfma_f32_32x32x16_bf16 v[128:143], v[112:115], v[160:163], v[128:143]
    ds_read_b128 v[180:183], v4 offset:31744
    s_waitcnt lgkmcnt(4)
    v_mfma_f32_32x32x16_bf16 v[128:143], v[116:119], v[164:167], v[128:143]
    ds_read_b128 v[160:163], v4 offset:32768
    s_waitcnt lgkmcnt(4)
    v_mfma_f32_32x32x16_bf16 v[128:143], v[120:123], v[168:171], v[128:143]
    ds_read_b128 v[164:167], v4 offset:33792
    s_waitcnt lgkmcnt(4)
    v_mfma_f32_32x32x16_bf16 v[128:143], v[124:127], v[172:175], v[128:143]
    ds_read_b128 v[168:171], v4 offset:34816
    s_waitcnt lgkmcnt(4)
    v_mfma_f32_32x32x16_bf16 v[144:159], v[16:19], v[176:179], 0
    ds_read_b128 v[172:175], v4 offset:35840
    s_waitcnt lgkmcnt(4)
    v_mfma_f32_32x32x16_bf16 v[144:159], v[20:23], v[180:183], v[144:159]
    v_fma_f32 v184, v233, v200, v216
    v_fma_f32 v185, v233, v201, v217
    v_fma_f32 v186, v233, v202, v218
    v_fma_f32 v187, v233, v203, v219
    v_fma_f32 v188, v233, v204, v220
    ds_read_b128 v[176:179], v4 offset:36864
    s_waitcnt lgkmcnt(4)
    v_mfma_f32_32x32x16_bf16 v[144:159], v[24:27], v[160:163], v[144:159]
    v_fma_f32 v189, v233, v205, v221
    v_fma_f32 v190, v233, v206, v222
    v_fma_f32 v191, v233, v207, v223
    v_fma_f32 v128, v232, v128, v184
    v_fma_f32 v129, v232, v129, v185
    ds_read_b128 v[180:183], v4 offset:37888
    s_waitcnt lgkmcnt(4)
    v_mfma_f32_32x32x16_bf16 v[144:159], v[28:31], v[164:167], v[144:159]
    v_fma_f32 v130, v232, v130, v186
    v_fma_f32 v131, v232, v131, v187
    v_fma_f32 v132, v232, v132, v188
    v_fma_f32 v133, v232, v133, v189
    v_fma_f32 v134, v232, v134, v190
    ds_read_b128 v[160:163], v4 offset:38912
    s_waitcnt lgkmcnt(4)
    v_mfma_f32_32x32x16_bf16 v[144:159], v[32:35], v[168:171], v[144:159]
    v_fma_f32 v135, v232, v135, v191
    v_exp_f32 v184, v128
    v_exp_f32 v185, v129
    v_exp_f32 v186, v130
    v_exp_f32 v187, v131
    ds_read_b128 v[164:167], v4 offset:39936
    s_waitcnt lgkmcnt(4)
    v_mfma_f32_32x32x16_bf16 v[144:159], v[36:39], v[172:175], v[144:159]
    v_exp_f32 v188, v132
    v_exp_f32 v189, v133
    v_exp_f32 v190, v134
    v_exp_f32 v191, v135
    v_add_f32 v184, 1.0, v184
    ds_read_b128 v[168:171], v4 offset:40960
    s_waitcnt lgkmcnt(4)
    v_mfma_f32_32x32x16_bf16 v[144:159], v[40:43], v[176:179], v[144:159]
    v_add_f32 v185, 1.0, v185
    v_add_f32 v186, 1.0, v186
    v_add_f32 v187, 1.0, v187
    v_add_f32 v188, 1.0, v188
    v_add_f32 v189, 1.0, v189
    ds_read_b128 v[172:175], v4 offset:41984
    s_waitcnt lgkmcnt(4)
    v_mfma_f32_32x32x16_bf16 v[144:159], v[44:47], v[180:183], v[144:159]
    v_add_f32 v190, 1.0, v190
    v_add_f32 v191, 1.0, v191
    v_rcp_f32 v184, v184
    v_rcp_f32 v185, v185
    v_rcp_f32 v186, v186
    ds_read_b128 v[176:179], v4 offset:43008
    s_waitcnt lgkmcnt(4)
    v_mfma_f32_32x32x16_bf16 v[144:159], v[48:51], v[160:163], v[144:159]
    v_rcp_f32 v187, v187
    v_rcp_f32 v188, v188
    v_rcp_f32 v189, v189
    v_rcp_f32 v190, v190
    v_rcp_f32 v191, v191
    ds_read_b128 v[180:183], v4 offset:44032
    s_waitcnt lgkmcnt(4)
    v_mfma_f32_32x32x16_bf16 v[144:159], v[52:55], v[164:167], v[144:159]
    v_mul_f32 v128, v128, v184
    v_mul_f32 v129, v129, v185
    v_mul_f32 v130, v130, v186
    v_mul_f32 v131, v131, v187
    v_mul_f32 v132, v132, v188
    ds_read_b128 v[160:163], v4 offset:45056
    s_waitcnt lgkmcnt(4)
    v_mfma_f32_32x32x16_bf16 v[144:159], v[56:59], v[168:171], v[144:159]
    v_mul_f32 v133, v133, v189
    v_mul_f32 v134, v134, v190
    v_mul_f32 v135, v135, v191
    v_fma_f32 v184, v233, v208, v224
    v_fma_f32 v185, v233, v209, v225
    ds_read_b128 v[164:167], v4 offset:46080
    s_waitcnt lgkmcnt(4)
    v_mfma_f32_32x32x16_bf16 v[144:159], v[60:63], v[172:175], v[144:159]
    v_fma_f32 v186, v233, v210, v226
    v_fma_f32 v187, v233, v211, v227
    v_fma_f32 v188, v233, v212, v228
    v_fma_f32 v189, v233, v213, v229
    v_fma_f32 v190, v233, v214, v230
    ds_read_b128 v[168:171], v4 offset:47104
    s_waitcnt lgkmcnt(4)
    v_mfma_f32_32x32x16_bf16 v[144:159], v[64:67], v[176:179], v[144:159]
    v_fma_f32 v191, v233, v215, v231
    v_fma_f32 v136, v232, v136, v184
    v_fma_f32 v137, v232, v137, v185
    v_fma_f32 v138, v232, v138, v186
    v_fma_f32 v139, v232, v139, v187
    ds_read_b128 v[172:175], v4 offset:48128
    s_waitcnt lgkmcnt(4)
    v_mfma_f32_32x32x16_bf16 v[144:159], v[68:71], v[180:183], v[144:159]
    v_fma_f32 v140, v232, v140, v188
    v_fma_f32 v141, v232, v141, v189
    v_fma_f32 v142, v232, v142, v190
    v_fma_f32 v143, v232, v143, v191
    v_exp_f32 v184, v136
    ds_read_b128 v[176:179], v4 offset:49152
    s_waitcnt lgkmcnt(4)
    v_mfma_f32_32x32x16_bf16 v[144:159], v[72:75], v[160:163], v[144:159]
    v_exp_f32 v185, v137
    v_exp_f32 v186, v138
    v_exp_f32 v187, v139
    v_exp_f32 v188, v140
    v_exp_f32 v189, v141
    ds_read_b128 v[180:183], v4 offset:50176
    s_waitcnt lgkmcnt(4)
    v_mfma_f32_32x32x16_bf16 v[144:159], v[76:79], v[164:167], v[144:159]
    v_exp_f32 v190, v142
    v_exp_f32 v191, v143
    v_add_f32 v184, 1.0, v184
    v_add_f32 v185, 1.0, v185
    v_add_f32 v186, 1.0, v186
    ds_read_b128 v[160:163], v4 offset:51200
    s_waitcnt lgkmcnt(4)
    v_mfma_f32_32x32x16_bf16 v[144:159], v[80:83], v[168:171], v[144:159]
    v_add_f32 v187, 1.0, v187
    v_add_f32 v188, 1.0, v188
    v_add_f32 v189, 1.0, v189
    v_add_f32 v190, 1.0, v190
    v_add_f32 v191, 1.0, v191
    ds_read_b128 v[164:167], v4 offset:52224
    s_waitcnt lgkmcnt(4)
    v_mfma_f32_32x32x16_bf16 v[144:159], v[84:87], v[172:175], v[144:159]
    v_rcp_f32 v184, v184
    v_rcp_f32 v185, v185
    v_rcp_f32 v186, v186
    v_rcp_f32 v187, v187
    v_rcp_f32 v188, v188
    ds_read_b128 v[168:171], v4 offset:53248
    s_waitcnt lgkmcnt(4)
    v_mfma_f32_32x32x16_bf16 v[144:159], v[88:91], v[176:179], v[144:159]
    v_rcp_f32 v189, v189
    v_rcp_f32 v190, v190
    v_rcp_f32 v191, v191
    v_mul_f32 v136, v136, v184
    v_mul_f32 v137, v137, v185
    ds_read_b128 v[172:175], v4 offset:54272
    s_waitcnt lgkmcnt(4)
    v_mfma_f32_32x32x16_bf16 v[144:159], v[92:95], v[180:183], v[144:159]
    v_mul_f32 v138, v138, v186
    v_mul_f32 v139, v139, v187
    v_mul_f32 v140, v140, v188
    v_mul_f32 v141, v141, v189
    v_mul_f32 v142, v142, v190
    s_waitcnt vmcnt(7)
    s_barrier
    ds_read_b128 v[176:179], v4 offset:55296
    s_waitcnt lgkmcnt(4)
    v_mfma_f32_32x32x16_bf16 v[144:159], v[96:99], v[160:163], v[144:159]
    v_mul_f32 v143, v143, v191
    v_cvt_pk_bf16_f32 v128, v128, v129
    v_cvt_pk_bf16_f32 v129, v130, v131
    v_cvt_pk_bf16_f32 v130, v132, v133
    v_cvt_pk_bf16_f32 v131, v134, v135
    ds_read_b128 v[180:183], v4 offset:56320
    s_waitcnt lgkmcnt(4)
    v_mfma_f32_32x32x16_bf16 v[144:159], v[100:103], v[164:167], v[144:159]
    v_cvt_pk_bf16_f32 v132, v136, v137
    v_cvt_pk_bf16_f32 v133, v138, v139
    v_cvt_pk_bf16_f32 v134, v140, v141
    v_cvt_pk_bf16_f32 v135, v142, v143
    buffer_store_dwordx4 v[128:131], v4, s[36:39], s13 offen sc1
    ds_read_b128 v[160:163], v11 offset:0
    s_waitcnt lgkmcnt(4)
    v_mfma_f32_32x32x16_bf16 v[144:159], v[104:107], v[168:171], v[144:159]
    buffer_store_dwordx4 v[132:135], v4, s[36:39], s13 offen offset:1024 sc1
    s_add_u32 s13, s13, 114688
    ds_read_b128 v[164:167], v11 offset:1024
    s_waitcnt lgkmcnt(4)
    v_mfma_f32_32x32x16_bf16 v[144:159], v[108:111], v[172:175], v[144:159]
    ds_read_b128 v[168:171], v11 offset:2048
    s_waitcnt lgkmcnt(4)
    v_mfma_f32_32x32x16_bf16 v[144:159], v[112:115], v[176:179], v[144:159]
    ds_read_b128 v[172:175], v11 offset:3072
    s_waitcnt lgkmcnt(4)
    v_mfma_f32_32x32x16_bf16 v[144:159], v[116:119], v[180:183], v[144:159]
    ds_read_b128 v[176:179], v11 offset:4096
    s_waitcnt lgkmcnt(4)
    v_mfma_f32_32x32x16_bf16 v[144:159], v[120:123], v[160:163], v[144:159]
    ds_read_b128 v[180:183], v11 offset:5120
    s_waitcnt lgkmcnt(4)
    v_mfma_f32_32x32x16_bf16 v[144:159], v[124:127], v[164:167], v[144:159]
    ds_read_b128 v[160:163], v11 offset:6144
    s_waitcnt lgkmcnt(4)
    v_mfma_f32_32x32x16_bf16 v[128:143], v[16:19], v[168:171], 0
    ds_read_b128 v[164:167], v11 offset:7168
    s_waitcnt lgkmcnt(4)
    v_mfma_f32_32x32x16_bf16 v[128:143], v[20:23], v[172:175], v[128:143]
    v_fma_f32 v184, v235, v200, v216
    v_fma_f32 v185, v235, v201, v217
    v_fma_f32 v186, v235, v202, v218
    v_fma_f32 v187, v235, v203, v219
    v_fma_f32 v188, v235, v204, v220
    ds_read_b128 v[168:171], v11 offset:8192
    s_waitcnt lgkmcnt(4)
    v_mfma_f32_32x32x16_bf16 v[128:143], v[24:27], v[176:179], v[128:143]
    v_fma_f32 v189, v235, v205, v221
    v_fma_f32 v190, v235, v206, v222
    v_fma_f32 v191, v235, v207, v223
    v_fma_f32 v144, v234, v144, v184
    v_fma_f32 v145, v234, v145, v185
    ds_read_b128 v[172:175], v11 offset:9216
    s_waitcnt lgkmcnt(4)
    v_mfma_f32_32x32x16_bf16 v[128:143], v[28:31], v[180:183], v[128:143]
    v_fma_f32 v146, v234, v146, v186
    v_fma_f32 v147, v234, v147, v187
    v_fma_f32 v148, v234, v148, v188
    v_fma_f32 v149, v234, v149, v189
    v_fma_f32 v150, v234, v150, v190
    ds_read_b128 v[176:179], v11 offset:10240
    s_waitcnt lgkmcnt(4)
    v_mfma_f32_32x32x16_bf16 v[128:143], v[32:35], v[160:163], v[128:143]
    v_fma_f32 v151, v234, v151, v191
    v_exp_f32 v184, v144
    v_exp_f32 v185, v145
    v_exp_f32 v186, v146
    v_exp_f32 v187, v147
    ds_read_b128 v[180:183], v11 offset:11264
    s_waitcnt lgkmcnt(4)
    v_mfma_f32_32x32x16_bf16 v[128:143], v[36:39], v[164:167], v[128:143]
    v_exp_f32 v188, v148
    v_exp_f32 v189, v149
    v_exp_f32 v190, v150
    v_exp_f32 v191, v151
    v_add_f32 v184, 1.0, v184
    ds_read_b128 v[160:163], v11 offset:12288
    s_waitcnt lgkmcnt(4)
    v_mfma_f32_32x32x16_bf16 v[128:143], v[40:43], v[168:171], v[128:143]
    v_add_f32 v185, 1.0, v185
    v_add_f32 v186, 1.0, v186
    v_add_f32 v187, 1.0, v187
    v_add_f32 v188, 1.0, v188
    v_add_f32 v189, 1.0, v189
    ds_read_b128 v[164:167], v11 offset:13312
    s_waitcnt lgkmcnt(4)
    v_mfma_f32_32x32x16_bf16 v[128:143], v[44:47], v[172:175], v[128:143]
    v_add_f32 v190, 1.0, v190
    v_add_f32 v191, 1.0, v191
    v_rcp_f32 v184, v184
    v_rcp_f32 v185, v185
    v_rcp_f32 v186, v186
    ds_read_b128 v[168:171], v11 offset:14336
    s_waitcnt lgkmcnt(4)
    v_mfma_f32_32x32x16_bf16 v[128:143], v[48:51], v[176:179], v[128:143]
    v_rcp_f32 v187, v187
    v_rcp_f32 v188, v188
    v_rcp_f32 v189, v189
    v_rcp_f32 v190, v190
    v_rcp_f32 v191, v191
    ds_read_b128 v[172:175], v11 offset:15360
    s_waitcnt lgkmcnt(4)
    v_mfma_f32_32x32x16_bf16 v[128:143], v[52:55], v[180:183], v[128:143]
    v_mul_f32 v144, v144, v184
    v_mul_f32 v145, v145, v185
    v_mul_f32 v146, v146, v186
    v_mul_f32 v147, v147, v187
    v_mul_f32 v148, v148, v188
    ds_read_b128 v[176:179], v11 offset:16384
    s_waitcnt lgkmcnt(4)
    v_mfma_f32_32x32x16_bf16 v[128:143], v[56:59], v[160:163], v[128:143]
    v_mul_f32 v149, v149, v189
    v_mul_f32 v150, v150, v190
    v_mul_f32 v151, v151, v191
    v_fma_f32 v184, v235, v208, v224
    v_fma_f32 v185, v235, v209, v225
    ds_read_b128 v[180:183], v11 offset:17408
    s_waitcnt lgkmcnt(4)
    v_mfma_f32_32x32x16_bf16 v[128:143], v[60:63], v[164:167], v[128:143]
    v_fma_f32 v186, v235, v210, v226
    v_fma_f32 v187, v235, v211, v227
    v_fma_f32 v188, v235, v212, v228
    v_fma_f32 v189, v235, v213, v229
    v_fma_f32 v190, v235, v214, v230
    ds_read_b128 v[160:163], v11 offset:18432
    s_waitcnt lgkmcnt(4)
    v_mfma_f32_32x32x16_bf16 v[128:143], v[64:67], v[168:171], v[128:143]
    v_fma_f32 v191, v235, v215, v231
    v_fma_f32 v152, v234, v152, v184
    v_fma_f32 v153, v234, v153, v185
    v_fma_f32 v154, v234, v154, v186
    v_fma_f32 v155, v234, v155, v187
    ds_read_b128 v[164:167], v11 offset:19456
    s_waitcnt lgkmcnt(4)
    v_mfma_f32_32x32x16_bf16 v[128:143], v[68:71], v[172:175], v[128:143]
    v_fma_f32 v156, v234, v156, v188
    v_fma_f32 v157, v234, v157, v189
    v_fma_f32 v158, v234, v158, v190
    v_fma_f32 v159, v234, v159, v191
    v_exp_f32 v184, v152
    ds_read_b128 v[168:171], v11 offset:20480
    s_waitcnt lgkmcnt(4)
    v_mfma_f32_32x32x16_bf16 v[128:143], v[72:75], v[176:179], v[128:143]
    v_exp_f32 v185, v153
    v_exp_f32 v186, v154
    v_exp_f32 v187, v155
    v_exp_f32 v188, v156
    v_exp_f32 v189, v157
    ds_read_b128 v[172:175], v11 offset:21504
    s_waitcnt lgkmcnt(4)
    v_mfma_f32_32x32x16_bf16 v[128:143], v[76:79], v[180:183], v[128:143]
    v_exp_f32 v190, v158
    v_exp_f32 v191, v159
    v_add_f32 v184, 1.0, v184
    v_add_f32 v185, 1.0, v185
    v_add_f32 v186, 1.0, v186
    ds_read_b128 v[176:179], v11 offset:22528
    s_waitcnt lgkmcnt(4)
    v_mfma_f32_32x32x16_bf16 v[128:143], v[80:83], v[160:163], v[128:143]
    v_add_f32 v187, 1.0, v187
    v_add_f32 v188, 1.0, v188
    v_add_f32 v189, 1.0, v189
    v_add_f32 v190, 1.0, v190
    v_add_f32 v191, 1.0, v191
    ds_read_b128 v[180:183], v11 offset:23552
    s_waitcnt lgkmcnt(4)
    v_mfma_f32_32x32x16_bf16 v[128:143], v[84:87], v[164:167], v[128:143]
    v_rcp_f32 v184, v184
    v_rcp_f32 v185, v185
    v_rcp_f32 v186, v186
    v_rcp_f32 v187, v187
    v_rcp_f32 v188, v188
    ds_read_b128 v[160:163], v11 offset:24576
    s_waitcnt lgkmcnt(4)
    v_mfma_f32_32x32x16_bf16 v[128:143], v[88:91], v[168:171], v[128:143]
    v_rcp_f32 v189, v189
    v_rcp_f32 v190, v190
    v_rcp_f32 v191, v191
    v_mul_f32 v152, v152, v184
    v_mul_f32 v153, v153, v185
    ds_read_b128 v[164:167], v11 offset:25600
    s_waitcnt lgkmcnt(4)
    v_mfma_f32_32x32x16_bf16 v[128:143], v[92:95], v[172:175], v[128:143]
    v_mul_f32 v154, v154, v186
    v_mul_f32 v155, v155, v187
    v_mul_f32 v156, v156, v188
    v_mul_f32 v157, v157, v189
    v_mul_f32 v158, v158, v190
    s_waitcnt vmcnt(2)
    s_barrier
    ds_read_b128 v[168:171], v11 offset:26624
    s_waitcnt lgkmcnt(4)
    v_mfma_f32_32x32x16_bf16 v[128:143], v[96:99], v[176:179], v[128:143]
    v_mul_f32 v159, v159, v191
    v_cvt_pk_bf16_f32 v144, v144, v145
    v_cvt_pk_bf16_f32 v145, v146, v147
    v_cvt_pk_bf16_f32 v146, v148, v149
    v_cvt_pk_bf16_f32 v147, v150, v151
    ds_read_b128 v[172:175], v11 offset:27648
    s_waitcnt lgkmcnt(4)
    v_mfma_f32_32x32x16_bf16 v[128:143], v[100:103], v[180:183], v[128:143]
    v_cvt_pk_bf16_f32 v148, v152, v153
    v_cvt_pk_bf16_f32 v149, v154, v155
    v_cvt_pk_bf16_f32 v150, v156, v157
    v_cvt_pk_bf16_f32 v151, v158, v159
    buffer_store_dwordx4 v[144:147], v4, s[36:39], s13 offen sc1
    ds_read_b128 v[176:179], v11 offset:28672
    s_waitcnt lgkmcnt(4)
    v_mfma_f32_32x32x16_bf16 v[128:143], v[104:107], v[160:163], v[128:143]
    buffer_store_dwordx4 v[148:151], v4, s[36:39], s13 offen offset:1024 sc1
    s_add_u32 s13, s13, 114688
    ds_read_b128 v[180:183], v11 offset:29696
    s_waitcnt lgkmcnt(4)
    v_mfma_f32_32x32x16_bf16 v[128:143], v[108:111], v[164:167], v[128:143]
    ds_read_b128 v[160:163], v11 offset:30720
    s_waitcnt lgkmcnt(4)
    v_mfma_f32_32x32x16_bf16 v[128:143], v[112:115], v[168:171], v[128:143]
    ds_read_b128 v[164:167], v11 offset:31744
    s_waitcnt lgkmcnt(4)
    v_mfma_f32_32x32x16_bf16 v[128:143], v[116:119], v[172:175], v[128:143]
    ds_read_b128 v[168:171], v11 offset:32768
    s_waitcnt lgkmcnt(4)
    v_mfma_f32_32x32x16_bf16 v[128:143], v[120:123], v[176:179], v[128:143]
    ds_read_b128 v[172:175], v11 offset:33792
    s_waitcnt lgkmcnt(4)
    v_mfma_f32_32x32x16_bf16 v[128:143], v[124:127], v[180:183], v[128:143]
    ds_read_b128 v[176:179], v11 offset:34816
    s_waitcnt lgkmcnt(4)
    v_mfma_f32_32x32x16_bf16 v[144:159], v[16:19], v[160:163], 0
    ds_read_b128 v[180:183], v11 offset:35840
    s_waitcnt lgkmcnt(4)
    v_mfma_f32_32x32x16_bf16 v[144:159], v[20:23], v[164:167], v[144:159]
    v_fma_f32 v184, v237, v200, v216
    v_fma_f32 v185, v237, v201, v217
    v_fma_f32 v186, v237, v202, v218
    v_fma_f32 v187, v237, v203, v219
    v_fma_f32 v188, v237, v204, v220
    ds_read_b128 v[160:163], v11 offset:36864
    s_waitcnt lgkmcnt(4)
    v_mfma_f32_32x32x16_bf16 v[144:159], v[24:27], v[168:171], v[144:159]
    v_fma_f32 v189, v237, v205, v221
    v_fma_f32 v190, v237, v206, v222
    v_fma_f32 v191, v237, v207, v223
    v_fma_f32 v128, v236, v128, v184
    v_fma_f32 v129, v236, v129, v185
    ds_read_b128 v[164:167], v11 offset:37888
    s_waitcnt lgkmcnt(4)
    v_mfma_f32_32x32x16_bf16 v[144:159], v[28:31], v[172:175], v[144:159]
    v_fma_f32 v130, v236, v130, v186
    v_fma_f32 v131, v236, v131, v187
    v_fma_f32 v132, v236, v132, v188
    v_fma_f32 v133, v236, v133, v189
    v_fma_f32 v134, v236, v134, v190
    ds_read_b128 v[168:171], v11 offset:38912
    s_waitcnt lgkmcnt(4)
    v_mfma_f32_32x32x16_bf16 v[144:159], v[32:35], v[176:179], v[144:159]
    v_fma_f32 v135, v236, v135, v191
    v_exp_f32 v184, v128
    v_exp_f32 v185, v129
    v_exp_f32 v186, v130
    v_exp_f32 v187, v131
    ds_read_b128 v[172:175], v11 offset:39936
    s_waitcnt lgkmcnt(4)
    v_mfma_f32_32x32x16_bf16 v[144:159], v[36:39], v[180:183], v[144:159]
    v_exp_f32 v188, v132
    v_exp_f32 v189, v133
    v_exp_f32 v190, v134
    v_exp_f32 v191, v135
    v_add_f32 v184, 1.0, v184
    ds_read_b128 v[176:179], v11 offset:40960
    s_waitcnt lgkmcnt(4)
    v_mfma_f32_32x32x16_bf16 v[144:159], v[40:43], v[160:163], v[144:159]
    v_add_f32 v185, 1.0, v185
    v_add_f32 v186, 1.0, v186
    v_add_f32 v187, 1.0, v187
    v_add_f32 v188, 1.0, v188
    v_add_f32 v189, 1.0, v189
    ds_read_b128 v[180:183], v11 offset:41984
    s_waitcnt lgkmcnt(4)
    v_mfma_f32_32x32x16_bf16 v[144:159], v[44:47], v[164:167], v[144:159]
    v_add_f32 v190, 1.0, v190
    v_add_f32 v191, 1.0, v191
    v_rcp_f32 v184, v184
    v_rcp_f32 v185, v185
    v_rcp_f32 v186, v186
    ds_read_b128 v[160:163], v11 offset:43008
    s_waitcnt lgkmcnt(4)
    v_mfma_f32_32x32x16_bf16 v[144:159], v[48:51], v[168:171], v[144:159]
    v_rcp_f32 v187, v187
    v_rcp_f32 v188, v188
    v_rcp_f32 v189, v189
    v_rcp_f32 v190, v190
    v_rcp_f32 v191, v191
    ds_read_b128 v[164:167], v11 offset:44032
    s_waitcnt lgkmcnt(4)
    v_mfma_f32_32x32x16_bf16 v[144:159], v[52:55], v[172:175], v[144:159]
    v_mul_f32 v128, v128, v184
    v_mul_f32 v129, v129, v185
    v_mul_f32 v130, v130, v186
    v_mul_f32 v131, v131, v187
    v_mul_f32 v132, v132, v188
    ds_read_b128 v[168:171], v11 offset:45056
    s_waitcnt lgkmcnt(4)
    v_mfma_f32_32x32x16_bf16 v[144:159], v[56:59], v[176:179], v[144:159]
    v_mul_f32 v133, v133, v189
    v_mul_f32 v134, v134, v190
    v_mul_f32 v135, v135, v191
    v_fma_f32 v184, v237, v208, v224
    v_fma_f32 v185, v237, v209, v225
    ds_read_b128 v[172:175], v11 offset:46080
    s_waitcnt lgkmcnt(4)
    v_mfma_f32_32x32x16_bf16 v[144:159], v[60:63], v[180:183], v[144:159]
    v_fma_f32 v186, v237, v210, v226
    v_fma_f32 v187, v237, v211, v227
    v_fma_f32 v188, v237, v212, v228
    v_fma_f32 v189, v237, v213, v229
    v_fma_f32 v190, v237, v214, v230
    ds_read_b128 v[176:179], v11 offset:47104
    s_waitcnt lgkmcnt(4)
    v_mfma_f32_32x32x16_bf16 v[144:159], v[64:67], v[160:163], v[144:159]
    v_fma_f32 v191, v237, v215, v231
    v_fma_f32 v136, v236, v136, v184
    v_fma_f32 v137, v236, v137, v185
    v_fma_f32 v138, v236, v138, v186
    v_fma_f32 v139, v236, v139, v187
    ds_read_b128 v[180:183], v11 offset:48128
    s_waitcnt lgkmcnt(4)
    v_mfma_f32_32x32x16_bf16 v[144:159], v[68:71], v[164:167], v[144:159]
    v_fma_f32 v140, v236, v140, v188
    v_fma_f32 v141, v236, v141, v189
    v_fma_f32 v142, v236, v142, v190
    v_fma_f32 v143, v236, v143, v191
    v_exp_f32 v184, v136
    ds_read_b128 v[160:163], v11 offset:49152
    s_waitcnt lgkmcnt(4)
    v_mfma_f32_32x32x16_bf16 v[144:159], v[72:75], v[168:171], v[144:159]
    v_exp_f32 v185, v137
    v_exp_f32 v186, v138
    v_exp_f32 v187, v139
    v_exp_f32 v188, v140
    v_exp_f32 v189, v141
    ds_read_b128 v[164:167], v11 offset:50176
    s_waitcnt lgkmcnt(4)
    v_mfma_f32_32x32x16_bf16 v[144:159], v[76:79], v[172:175], v[144:159]
    v_exp_f32 v190, v142
    v_exp_f32 v191, v143
    v_add_f32 v184, 1.0, v184
    v_add_f32 v185, 1.0, v185
    v_add_f32 v186, 1.0, v186
    ds_read_b128 v[168:171], v11 offset:51200
    s_waitcnt lgkmcnt(4)
    v_mfma_f32_32x32x16_bf16 v[144:159], v[80:83], v[176:179], v[144:159]
    v_add_f32 v187, 1.0, v187
    v_add_f32 v188, 1.0, v188
    v_add_f32 v189, 1.0, v189
    v_add_f32 v190, 1.0, v190
    v_add_f32 v191, 1.0, v191
    ds_read_b128 v[172:175], v11 offset:52224
    s_waitcnt lgkmcnt(4)
    v_mfma_f32_32x32x16_bf16 v[144:159], v[84:87], v[180:183], v[144:159]
    v_rcp_f32 v184, v184
    v_rcp_f32 v185, v185
    v_rcp_f32 v186, v186
    v_rcp_f32 v187, v187
    v_rcp_f32 v188, v188
    ds_read_b128 v[176:179], v11 offset:53248
    s_waitcnt lgkmcnt(4)
    v_mfma_f32_32x32x16_bf16 v[144:159], v[88:91], v[160:163], v[144:159]
    v_rcp_f32 v189, v189
    v_rcp_f32 v190, v190
    v_rcp_f32 v191, v191
    v_mul_f32 v136, v136, v184
    v_mul_f32 v137, v137, v185
    ds_read_b128 v[180:183], v11 offset:54272
    s_waitcnt lgkmcnt(4)
    v_mfma_f32_32x32x16_bf16 v[144:159], v[92:95], v[164:167], v[144:159]
    v_mul_f32 v138, v138, v186
    v_mul_f32 v139, v139, v187
    v_mul_f32 v140, v140, v188
    v_mul_f32 v141, v141, v189
    v_mul_f32 v142, v142, v190
    ds_read_b128 v[160:163], v11 offset:55296
    s_waitcnt lgkmcnt(4)
    v_mfma_f32_32x32x16_bf16 v[144:159], v[96:99], v[168:171], v[144:159]
    v_mul_f32 v143, v143, v191
    v_cvt_pk_bf16_f32 v128, v128, v129
    v_cvt_pk_bf16_f32 v129, v130, v131
    v_cvt_pk_bf16_f32 v130, v132, v133
    v_cvt_pk_bf16_f32 v131, v134, v135
    ds_read_b128 v[164:167], v11 offset:56320
    s_waitcnt lgkmcnt(4)
    v_mfma_f32_32x32x16_bf16 v[144:159], v[100:103], v[172:175], v[144:159]
    v_cvt_pk_bf16_f32 v132, v136, v137
    v_cvt_pk_bf16_f32 v133, v138, v139
    v_cvt_pk_bf16_f32 v134, v140, v141
    v_cvt_pk_bf16_f32 v135, v142, v143
    buffer_store_dwordx4 v[128:131], v4, s[36:39], s13 offen sc1
    ds_read_b128 v[168:171], v11 offset:57344
    s_waitcnt lgkmcnt(4)
    v_mfma_f32_32x32x16_bf16 v[144:159], v[104:107], v[176:179], v[144:159]
    buffer_store_dwordx4 v[132:135], v4, s[36:39], s13 offen offset:1024 sc1
    s_add_u32 s13, s13, 114688
    ds_read_b128 v[172:175], v11 offset:58368
    s_waitcnt lgkmcnt(4)
    v_mfma_f32_32x32x16_bf16 v[144:159], v[108:111], v[180:183], v[144:159]
    s_waitcnt lgkmcnt(3)
    v_mfma_f32_32x32x16_bf16 v[144:159], v[112:115], v[160:163], v[144:159]
    s_waitcnt lgkmcnt(2)
    v_mfma_f32_32x32x16_bf16 v[144:159], v[116:119], v[164:167], v[144:159]
    s_waitcnt lgkmcnt(1)
    v_mfma_f32_32x32x16_bf16 v[144:159], v[120:123], v[168:171], v[144:159]
    s_waitcnt lgkmcnt(0)
    v_mfma_f32_32x32x16_bf16 v[144:159], v[124:127], v[172:175], v[144:159]
    v_fma_f32 v184, v239, v200, v216
    v_fma_f32 v185, v239, v201, v217
    v_fma_f32 v186, v239, v202, v218
    v_fma_f32 v187, v239, v203, v219
    v_fma_f32 v188, v239, v204, v220
    v_fma_f32 v189, v239, v205, v221
    v_fma_f32 v190, v239, v206, v222
    v_fma_f32 v191, v239, v207, v223
    s_nop 3
    v_fma_f32 v144, v238, v144, v184
    v_fma_f32 v145, v238, v145, v185
    v_fma_f32 v146, v238, v146, v186
    v_fma_f32 v147, v238, v147, v187
    v_fma_f32 v148, v238, v148, v188
    v_fma_f32 v149, v238, v149, v189
    v_fma_f32 v150, v238, v150, v190
    v_fma_f32 v151, v238, v151, v191
    v_exp_f32 v184, v144
    v_exp_f32 v185, v145
    v_exp_f32 v186, v146
    v_exp_f32 v187, v147
    v_exp_f32 v188, v148
    v_exp_f32 v189, v149
    v_exp_f32 v190, v150
    v_exp_f32 v191, v151
    v_add_f32 v184, 1.0, v184
    v_add_f32 v185, 1.0, v185
    v_add_f32 v186, 1.0, v186
    v_add_f32 v187, 1.0, v187
    v_add_f32 v188, 1.0, v188
    v_add_f32 v189, 1.0, v189
    v_add_f32 v190, 1.0, v190
    v_add_f32 v191, 1.0, v191
    v_rcp_f32 v184, v184
    v_rcp_f32 v185, v185
    v_rcp_f32 v186, v186
    v_rcp_f32 v187, v187
    v_rcp_f32 v188, v188
    v_rcp_f32 v189, v189
    v_rcp_f32 v190, v190
    v_rcp_f32 v191, v191
    v_mul_f32 v144, v144, v184
    v_mul_f32 v145, v145, v185
    v_mul_f32 v146, v146, v186
    v_mul_f32 v147, v147, v187
    v_mul_f32 v148, v148, v188
    v_mul_f32 v149, v149, v189
    v_mul_f32 v150, v150, v190
    v_mul_f32 v151, v151, v191
    v_fma_f32 v184, v239, v208, v224
    v_fma_f32 v185, v239, v209, v225
    v_fma_f32 v186, v239, v210, v226
    v_fma_f32 v187, v239, v211, v227
    v_fma_f32 v188, v239, v212, v228
    v_fma_f32 v189, v239, v213, v229
    v_fma_f32 v190, v239, v214, v230
    v_fma_f32 v191, v239, v215, v231
    v_fma_f32 v152, v238, v152, v184
    v_fma_f32 v153, v238, v153, v185
    v_fma_f32 v154, v238, v154, v186
    v_fma_f32 v155, v238, v155, v187
    v_fma_f32 v156, v238, v156, v188
    v_fma_f32 v157, v238, v157, v189
    v_fma_f32 v158, v238, v158, v190
    v_fma_f32 v159, v238, v159, v191
    v_exp_f32 v184, v152
    v_exp_f32 v185, v153
    v_exp_f32 v186, v154
    v_exp_f32 v187, v155
    v_exp_f32 v188, v156
    v_exp_f32 v189, v157
    v_exp_f32 v190, v158
    v_exp_f32 v191, v159
    v_add_f32 v184, 1.0, v184
    v_add_f32 v185, 1.0, v185
    v_add_f32 v186, 1.0, v186
    v_add_f32 v187, 1.0, v187
    v_add_f32 v188, 1.0, v188
    v_add_f32 v189, 1.0, v189
    v_add_f32 v190, 1.0, v190
    v_add_f32 v191, 1.0, v191
    v_rcp_f32 v184, v184
    v_rcp_f32 v185, v185
    v_rcp_f32 v186, v186
    v_rcp_f32 v187, v187
    v_rcp_f32 v188, v188
    v_rcp_f32 v189, v189
    v_rcp_f32 v190, v190
    v_rcp_f32 v191, v191
    v_mul_f32 v152, v152, v184
    v_mul_f32 v153, v153, v185
    v_mul_f32 v154, v154, v186
    v_mul_f32 v155, v155, v187
    v_mul_f32 v156, v156, v188
    v_mul_f32 v157, v157, v189
    v_mul_f32 v158, v158, v190
    v_mul_f32 v159, v159, v191
    v_cvt_pk_bf16_f32 v144, v144, v145
    v_cvt_pk_bf16_f32 v145, v146, v147
    v_cvt_pk_bf16_f32 v146, v148, v149
    v_cvt_pk_bf16_f32 v147, v150, v151
    v_cvt_pk_bf16_f32 v148, v152, v153
    v_cvt_pk_bf16_f32 v149, v154, v155
    v_cvt_pk_bf16_f32 v150, v156, v157
    v_cvt_pk_bf16_f32 v151, v158, v159
    buffer_store_dwordx4 v[144:147], v4, s[36:39], s13 offen sc1
    buffer_store_dwordx4 v[148:151], v4, s[36:39], s13 offen offset:1024 sc1
K5_END:
    s_endpgm
.globl ffn2_kernel
.p2align 8
.type ffn2_kernel,@function
ffn2_kernel:
    s_cmp_ge_u32 s2, 224
    s_cbranch_scc1 K6_END
    s_load_dwordx16 s[16:31], s[0:1], 0
    s_load_dwordx2 s[32:33], s[0:1], 64
    s_load_dwordx2 s[34:35], s[0:1], 80
    s_waitcnt lgkmcnt(0)
    s_mov_b32 s36, s34
    s_mov_b32 s37, s35
    s_mov_b32 s38, 0x1b00000
    s_mov_b32 s39, 0x00020000
    s_mov_b32 s40, s32
    s_mov_b32 s41, s33
    s_mov_b32 s42, 0x1c0000
    s_mov_b32 s43, 0x00020000
    v_lshrrev_b32 v8, 6, v0
    s_nop 0
    v_readfirstlane_b32 s6, v8
    v_and_b32 v1, 63, v0
    v_and_b32 v2, 31, v0
    v_bfe_u32 v3, v0, 5, 1
    v_lshlrev_b32 v4, 4, v1
    s_and_b32 s3, s2, 31
    s_lshr_b32 s4, s2, 5
    s_mul_i32 s7, s3, 229376
    s_mul_i32 s8, s6, 28672
    s_add_u32 s7, s7, s8
    s_add_u32 s7, s7, 0x1100000
    s_add_u32 s9, s7, 114688
    s_mul_i32 s10, s4, 229376
    s_add_u32 s10, s10, s8
    s_add_u32 s10, s10, 0x500000
    s_add_u32 s11, s10, 114688
    buffer_load_dwordx4 v[80:83], v4, s[36:39], s7 offen offset:0
    buffer_load_dwordx4 v[84:87], v4, s[36:39], s9 offen offset:0
    buffer_load_dwordx4 v[88:91], v4, s[36:39], s10 offen offset:0
    buffer_load_dwordx4 v[92:95], v4, s[36:39], s11 offen offset:0
    buffer_load_dwordx4 v[96:99], v4, s[36:39], s7 offen offset:1024
    buffer_load_dwordx4 v[100:103], v4, s[36:39], s9 offen offset:1024
    buffer_load_dwordx4 v[104:107], v4, s[36:39], s10 offen offset:1024
    buffer_load_dwordx4 v[108:111], v4, s[36:39], s11 offen offset:1024
    buffer_load_dwordx4 v[112:115], v4, s[36:39], s7 offen offset:2048
    buffer_load_dwordx4 v[116:119], v4, s[36:39], s9 offen offset:2048
    buffer_load_dwordx4 v[120:123], v4, s[36:39], s10 offen offset:2048
    buffer_load_dwordx4 v[124:127], v4, s[36:39], s11 offen offset:2048
    buffer_load_dwordx4 v[128:131], v4, s[36:39], s7 offen offset:3072
    buffer_load_dwordx4 v[132:135], v4, s[36:39], s9 offen offset:3072
    buffer_load_dwordx4 v[136:139], v4, s[36:39], s10 offen offset:3072
    buffer_load_dwordx4 v[140:143], v4, s[36:39], s11 offen offset:3072
    s_add_u32 s7, s7, 4096
    s_add_u32 s9, s9, 4096
    s_add_u32 s10, s10, 4096
    s_add_u32 s11, s11, 4096
    buffer_load_dwordx4 v[144:147], v4, s[36:39], s7 offen offset:0
    buffer_load_dwordx4 v[148:151], v4, s[36:39], s9 offen offset:0
    buffer_load_dwordx4 v[152:155], v4, s[36:39], s10 offen offset:0
    buffer_load_dwordx4 v[156:159], v4, s[36:39], s11 offen offset:0
    buffer_load_dwordx4 v[160:163], v4, s[36:39], s7 offen offset:1024
    buffer_load_dwordx4 v[164:167], v4, s[36:39], s9 offen offset:1024
    buffer_load_dwordx4 v[168:171], v4, s[36:39], s10 offen offset:1024
    buffer_load_dwordx4 v[172:175], v4, s[36:39], s11 offen offset:1024
    buffer_load_dwordx4 v[176:179], v4, s[36:39], s7 offen offset:2048
    buffer_load_dwordx4 v[180:183], v4, s[36:39], s9 offen offset:2048
    buffer_load_dwordx4 v[184:187], v4, s[36:39], s10 offen offset:2048
    buffer_load_dwordx4 v[188:191], v4, s[36:39], s11 offen offset:2048
    buffer_load_dwordx4 v[192:195], v4, s[36:39], s7 offen offset:3072
    buffer_load_dwordx4 v[196:199], v4, s[36:39], s9 offen offset:3072
    buffer_load_dwordx4 v[200:203], v4, s[36:39], s10 offen offset:3072
    buffer_load_dwordx4 v[204:207], v4, s[36:39], s11 offen offset:3072
    s_add_u32 s7, s7, 4096
    s_add_u32 s9, s9, 4096
    s_add_u32 s10, s10, 4096
    s_add_u32 s11, s11, 4096
    buffer_load_dwordx4 v[208:211], v4, s[36:39], s7 offen offset:0
    buffer_load_dwordx4 v[212:215], v4, s[36:39], s9 offen offset:0
    buffer_load_dwordx4 v[216:219], v4, s[36:39], s10 offen offset:0
    buffer_load_dwordx4 v[220:223], v4, s[36:39], s11 offen offset:0
    s_lshr_b32 s13, s6, 1
    s_and_b32 s14, s6, 1
    s_lshl_b32 s15, s3, 1
    s_add_u32 s15, s15, s13
    s_lshl_b32 s12, s4, 1
    s_add_u32 s12, s12, s14
    s_mul_i32 s44, s15, 14
    s_add_u32 s44, s44, s12
    s_lshl_b32 s44, s44, 11
    s_add_u32 s44, s44, 0xf00000
    buffer_load_dwordx4 v[240:243], v4, s[36:39], s44 offen
    buffer_load_dwordx4 v[244:247], v4, s[36:39], s44 offen offset:1024
    v_mov_b32 v16, 0
    v_mov_b32 v17, 0
    v_mov_b32 v18, 0
    v_mov_b32 v19, 0
    v_mov_b32 v20, 0
    v_mov_b32 v21, 0
    v_mov_b32 v22, 0
    v_mov_b32 v23, 0
    v_mov_b32 v24, 0
    v_mov_b32 v25, 0
    v_mov_b32 v26, 0
    v_mov_b32 v27, 0
    v_mov_b32 v28, 0
    v_mov_b32 v29, 0
    v_mov_b32 v30, 0
    v_mov_b32 v31, 0
    v_mov_b32 v32, 0
    v_mov_b32 v33, 0
    v_mov_b32 v34, 0
    v_mov_b32 v35, 0
    v_mov_b32 v36, 0
    v_mov_b32 v37, 0
    v_mov_b32 v38, 0
    v_mov_b32 v39, 0
    v_mov_b32 v40, 0
    v_mov_b32 v41, 0
    v_mov_b32 v42, 0
    v_mov_b32 v43, 0
    v_mov_b32 v44, 0
    v_mov_b32 v45, 0
    v_mov_b32 v46, 0
    v_mov_b32 v47, 0
    v_mov_b32 v48, 0
    v_mov_b32 v49, 0
    v_mov_b32 v50, 0
    v_mov_b32 v51, 0
    v_mov_b32 v52, 0
    v_mov_b32 v53, 0
    v_mov_b32 v54, 0
    v_mov_b32 v55, 0
    v_mov_b32 v56, 0
    v_mov_b32 v57, 0
    v_mov_b32 v58, 0
    v_mov_b32 v59, 0
    v_mov_b32 v60, 0
    v_mov_b32 v61, 0
    v_mov_b32 v62, 0
    v_mov_b32 v63, 0
    v_mov_b32 v64, 0
    v_mov_b32 v65, 0
    v_mov_b32 v66, 0
    v_mov_b32 v67, 0
    v_mov_b32 v68, 0
    v_mov_b32 v69, 0
    v_mov_b32 v70, 0
    v_mov_b32 v71, 0
    v_mov_b32 v72, 0
    v_mov_b32 v73, 0
    v_mov_b32 v74, 0
    v_mov_b32 v75, 0
    v_mov_b32 v76, 0
    v_mov_b32 v77, 0
    v_mov_b32 v78, 0
    v_mov_b32 v79, 0
    buffer_load_dwordx4 v[224:227], v4, s[36:39], s7 offen offset:1024
    buffer_load_dwordx4 v[228:231], v4, s[36:39], s9 offen offset:1024
    buffer_load_dwordx4 v[232:235], v4, s[36:39], s10 offen offset:1024
    buffer_load_dwordx4 v[236:239], v4, s[36:39], s11 offen offset:1024
    s_waitcnt vmcnt(38)
    v_mfma_f32_32x32x16_bf16 v[16:31], v[88:91], v[80:83], v[16:31]
    v_mfma_f32_32x32x16_bf16 v[32:47], v[92:95], v[80:83], v[32:47]
    v_mfma_f32_32x32x16_bf16 v[48:63], v[88:91], v[84:87], v[48:63]
    v_mfma_f32_32x32x16_bf16 v[64:79], v[92:95], v[84:87], v[64:79]
    buffer_load_dwordx4 v[80:83], v4, s[36:39], s7 offen offset:2048
    buffer_load_dwordx4 v[84:87], v4, s[36:39], s9 offen offset:2048
    buffer_load_dwordx4 v[88:91], v4, s[36:39], s10 offen offset:2048
    buffer_load_dwordx4 v[92:95], v4, s[36:39], s11 offen offset:2048
    s_waitcnt vmcnt(38)
    v_mfma_f32_32x32x16_bf16 v[16:31], v[104:107], v[96:99], v[16:31]
    v_mfma_f32_32x32x16_bf16 v[32:47], v[108:111], v[96:99], v[32:47]
    v_mfma_f32_32x32x16_bf16 v[48:63], v[104:107], v[100:103], v[48:63]
    v_mfma_f32_32x32x16_bf16 v[64:79], v[108:111], v[100:103], v[64:79]
    buffer_load_dwordx4 v[96:99], v4, s[36:39], s7 offen offset:3072
    buffer_load_dwordx4 v[100:103], v4, s[36:39], s9 offen offset:3072
    buffer_load_dwordx4 v[104:107], v4, s[36:39], s10 offen offset:3072
    buffer_load_dwordx4 v[108:111], v4, s[36:39], s11 offen offset:3072
    s_add_u32 s7, s7, 4096
    s_add_u32 s9, s9, 4096
    s_add_u32 s10, s10, 4096
    s_add_u32 s11, s11, 4096
    s_waitcnt vmcnt(38)
    v_mfma_f32_32x32x16_bf16 v[16:31], v[120:123], v[112:115], v[16:31]
    v_mfma_f32_32x32x16_bf16 v[32:47], v[124:127], v[112:115], v[32:47]
    v_mfma_f32_32x32x16_bf16 v[48:63], v[120:123], v[116:119], v[48:63]
    v_mfma_f32_32x32x16_bf16 v[64:79], v[124:127], v[116:119], v[64:79]
    buffer_load_dwordx4 v[112:115], v4, s[36:39], s7 offen offset:0
    buffer_load_dwordx4 v[116:119], v4, s[36:39], s9 offen offset:0
    buffer_load_dwordx4 v[120:123], v4, s[36:39], s10 offen offset:0
    buffer_load_dwordx4 v[124:127], v4, s[36:39], s11 offen offset:0
    s_waitcnt vmcnt(38)
    v_mfma_f32_32x32x16_bf16 v[16:31], v[136:139], v[128:131], v[16:31]
    v_mfma_f32_32x32x16_bf16 v[32:47], v[140:143], v[128:131], v[32:47]
    v_mfma_f32_32x32x16_bf16 v[48:63], v[136:139], v[132:135], v[48:63]
    v_mfma_f32_32x32x16_bf16 v[64:79], v[140:143], v[132:135], v[64:79]
    buffer_load_dwordx4 v[128:131], v4, s[36:39], s7 offen offset:1024
    buffer_load_dwordx4 v[132:135], v4, s[36:39], s9 offen offset:1024
    buffer_load_dwordx4 v[136:139], v4, s[36:39], s10 offen offset:1024
    buffer_load_dwordx4 v[140:143], v4, s[36:39], s11 offen offset:1024
    s_waitcnt vmcnt(38)
    v_mfma_f32_32x32x16_bf16 v[16:31], v[152:155], v[144:147], v[16:31]
    v_mfma_f32_32x32x16_bf16 v[32:47], v[156:159], v[144:147], v[32:47]
    v_mfma_f32_32x32x16_bf16 v[48:63], v[152:155], v[148:151], v[48:63]
    v_mfma_f32_32x32x16_bf16 v[64:79], v[156:159], v[148:151], v[64:79]
    buffer_load_dwordx4 v[144:147], v4, s[36:39], s7 offen offset:2048
    buffer_load_dwordx4 v[148:151], v4, s[36:39], s9 offen offset:2048
    buffer_load_dwordx4 v[152:155], v4, s[36:39], s10 offen offset:2048
    buffer_load_dwordx4 v[156:159], v4, s[36:39], s11 offen offset:2048
    s_waitcnt vmcnt(38)
    v_mfma_f32_32x32x16_bf16 v[16:31], v[168:171], v[160:163], v[16:31]
    v_mfma_f32_32x32x16_bf16 v[32:47], v[172:175], v[160:163], v[32:47]
    v_mfma_f32_32x32x16_bf16 v[48:63], v[168:171], v[164:167], v[48:63]
    v_mfma_f32_32x32x16_bf16 v[64:79], v[172:175], v[164:167], v[64:79]
    buffer_load_dwordx4 v[160:163], v4, s[36:39], s7 offen offset:3072
    buffer_load_dwordx4 v[164:167], v4, s[36:39], s9 offen offset:3072
    buffer_load_dwordx4 v[168:171], v4, s[36:39], s10 offen offset:3072
    buffer_load_dwordx4 v[172:175], v4, s[36:39], s11 offen offset:3072
    s_add_u32 s7, s7, 4096
    s_add_u32 s9, s9, 4096
    s_add_u32 s10, s10, 4096
    s_add_u32 s11, s11, 4096
    s_waitcnt vmcnt(38)
    v_mfma_f32_32x32x16_bf16 v[16:31], v[184:187], v[176:179], v[16:31]
    v_mfma_f32_32x32x16_bf16 v[32:47], v[188:191], v[176:179], v[32:47]
    v_mfma_f32_32x32x16_bf16 v[48:63], v[184:187], v[180:183], v[48:63]
    v_mfma_f32_32x32x16_bf16 v[64:79], v[188:191], v[180:183], v[64:79]
    buffer_load_dwordx4 v[176:179], v4, s[36:39], s7 offen offset:0
    buffer_load_dwordx4 v[180:183], v4, s[36:39], s9 offen offset:0
    buffer_load_dwordx4 v[184:187], v4, s[36:39], s10 offen offset:0
    buffer_load_dwordx4 v[188:191], v4, s[36:39], s11 offen offset:0
    s_waitcnt vmcnt(38)
    v_mfma_f32_32x32x16_bf16 v[16:31], v[200:203], v[192:195], v[16:31]
    v_mfma_f32_32x32x16_bf16 v[32:47], v[204:207], v[192:195], v[32:47]
    v_mfma_f32_32x32x16_bf16 v[48:63], v[200:203], v[196:199], v[48:63]
    v_mfma_f32_32x32x16_bf16 v[64:79], v[204:207], v[196:199], v[64:79]
    buffer_load_dwordx4 v[192:195], v4, s[36:39], s7 offen offset:1024
    buffer_load_dwordx4 v[196:199], v4, s[36:39], s9 offen offset:1024
    buffer_load_dwordx4 v[200:203], v4, s[36:39], s10 offen offset:1024
    buffer_load_dwordx4 v[204:207], v4, s[36:39], s11 offen offset:1024
    s_waitcnt vmcnt(38)
    v_mfma_f32_32x32x16_bf16 v[16:31], v[216:219], v[208:211], v[16:31]
    v_mfma_f32_32x32x16_bf16 v[32:47], v[220:223], v[208:211], v[32:47]
    v_mfma_f32_32x32x16_bf16 v[48:63], v[216:219], v[212:215], v[48:63]
    v_mfma_f32_32x32x16_bf16 v[64:79], v[220:223], v[212:215], v[64:79]
    buffer_load_dwordx4 v[208:211], v4, s[36:39], s7 offen offset:2048
    buffer_load_dwordx4 v[212:215], v4, s[36:39], s9 offen offset:2048
    buffer_load_dwordx4 v[216:219], v4, s[36:39], s10 offen offset:2048
    buffer_load_dwordx4 v[220:223], v4, s[36:39], s11 offen offset:2048
    s_waitcnt vmcnt(36)
    v_mfma_f32_32x32x16_bf16 v[16:31], v[232:235], v[224:227], v[16:31]
    v_mfma_f32_32x32x16_bf16 v[32:47], v[236:239], v[224:227], v[32:47]
    v_mfma_f32_32x32x16_bf16 v[48:63], v[232:235], v[228:231], v[48:63]
    v_mfma_f32_32x32x16_bf16 v[64:79], v[236:239], v[228:231], v[64:79]
    buffer_load_dwordx4 v[224:227], v4, s[36:39], s7 offen offset:3072
    buffer_load_dwordx4 v[228:231], v4, s[36:39], s9 offen offset:3072
    buffer_load_dwordx4 v[232:235], v4, s[36:39], s10 offen offset:3072
    buffer_load_dwordx4 v[236:239], v4, s[36:39], s11 offen offset:3072
    s_add_u32 s7, s7, 4096
    s_add_u32 s9, s9, 4096
    s_add_u32 s10, s10, 4096
    s_add_u32 s11, s11, 4096
    s_waitcnt vmcnt(36)
    v_mfma_f32_32x32x16_bf16 v[16:31], v[88:91], v[80:83], v[16:31]
    v_mfma_f32_32x32x16_bf16 v[32:47], v[92:95], v[80:83], v[32:47]
    v_mfma_f32_32x32x16_bf16 v[48:63], v[88:91], v[84:87], v[48:63]
    v_mfma_f32_32x32x16_bf16 v[64:79], v[92:95], v[84:87], v[64:79]
    buffer_load_dwordx4 v[80:83], v4, s[36:39], s7 offen offset:0
    buffer_load_dwordx4 v[84:87], v4, s[36:39], s9 offen offset:0
    buffer_load_dwordx4 v[88:91], v4, s[36:39], s10 offen offset:0
    buffer_load_dwordx4 v[92:95], v4, s[36:39], s11 offen offset:0
    s_waitcnt vmcnt(36)
    v_mfma_f32_32x32x16_bf16 v[16:31], v[104:107], v[96:99], v[16:31]
    v_mfma_f32_32x32x16_bf16 v[32:47], v[108:111], v[96:99], v[32:47]
    v_mfma_f32_32x32x16_bf16 v[48:63], v[104:107], v[100:103], v[48:63]
    v_mfma_f32_32x32x16_bf16 v[64:79], v[108:111], v[100:103], v[64:79]
    buffer_load_dwordx4 v[96:99], v4, s[36:39], s7 offen offset:1024
    buffer_load_dwordx4 v[100:103], v4, s[36:39], s9 offen offset:1024
    buffer_load_dwordx4 v[104:107], v4, s[36:39], s10 offen offset:1024
    buffer_load_dwordx4 v[108:111], v4, s[36:39], s11 offen offset:1024
    s_waitcnt vmcnt(36)
    v_mfma_f32_32x32x16_bf16 v[16:31], v[120:123], v[112:115], v[16:31]
    v_mfma_f32_32x32x16_bf16 v[32:47], v[124:127], v[112:115], v[32:47]
    v_mfma_f32_32x32x16_bf16 v[48:63], v[120:123], v[116:119], v[48:63]
    v_mfma_f32_32x32x16_bf16 v[64:79], v[124:127], v[116:119], v[64:79]
    buffer_load_dwordx4 v[112:115], v4, s[36:39], s7 offen offset:2048
    buffer_load_dwordx4 v[116:119], v4, s[36:39], s9 offen offset:2048
    buffer_load_dwordx4 v[120:123], v4, s[36:39], s10 offen offset:2048
    buffer_load_dwordx4 v[124:127], v4, s[36:39], s11 offen offset:2048
    s_waitcnt vmcnt(36)
    v_mfma_f32_32x32x16_bf16 v[16:31], v[136:139], v[128:131], v[16:31]
    v_mfma_f32_32x32x16_bf16 v[32:47], v[140:143], v[128:131], v[32:47]
    v_mfma_f32_32x32x16_bf16 v[48:63], v[136:139], v[132:135], v[48:63]
    v_mfma_f32_32x32x16_bf16 v[64:79], v[140:143], v[132:135], v[64:79]
    buffer_load_dwordx4 v[128:131], v4, s[36:39], s7 offen offset:3072
    buffer_load_dwordx4 v[132:135], v4, s[36:39], s9 offen offset:3072
    buffer_load_dwordx4 v[136:139], v4, s[36:39], s10 offen offset:3072
    buffer_load_dwordx4 v[140:143], v4, s[36:39], s11 offen offset:3072
    s_add_u32 s7, s7, 4096
    s_add_u32 s9, s9, 4096
    s_add_u32 s10, s10, 4096
    s_add_u32 s11, s11, 4096
    s_waitcnt vmcnt(36)
    v_mfma_f32_32x32x16_bf16 v[16:31], v[152:155], v[144:147], v[16:31]
    v_mfma_f32_32x32x16_bf16 v[32:47], v[156:159], v[144:147], v[32:47]
    v_mfma_f32_32x32x16_bf16 v[48:63], v[152:155], v[148:151], v[48:63]
    v_mfma_f32_32x32x16_bf16 v[64:79], v[156:159], v[148:151], v[64:79]
    buffer_load_dwordx4 v[144:147], v4, s[36:39], s7 offen offset:0
    buffer_load_dwordx4 v[148:151], v4, s[36:39], s9 offen offset:0
    buffer_load_dwordx4 v[152:155], v4, s[36:39], s10 offen offset:0
    buffer_load_dwordx4 v[156:159], v4, s[36:39], s11 offen offset:0
    s_waitcnt vmcnt(36)
    v_mfma_f32_32x32x16_bf16 v[16:31], v[168:171], v[160:163], v[16:31]
    v_mfma_f32_32x32x16_bf16 v[32:47], v[172:175], v[160:163], v[32:47]
    v_mfma_f32_32x32x16_bf16 v[48:63], v[168:171], v[164:167], v[48:63]
    v_mfma_f32_32x32x16_bf16 v[64:79], v[172:175], v[164:167], v[64:79]
    buffer_load_dwordx4 v[160:163], v4, s[36:39], s7 offen offset:1024
    buffer_load_dwordx4 v[164:167], v4, s[36:39], s9 offen offset:1024
    buffer_load_dwordx4 v[168:171], v4, s[36:39], s10 offen offset:1024
    buffer_load_dwordx4 v[172:175], v4, s[36:39], s11 offen offset:1024
    s_waitcnt vmcnt(36)
    v_mfma_f32_32x32x16_bf16 v[16:31], v[184:187], v[176:179], v[16:31]
    v_mfma_f32_32x32x16_bf16 v[32:47], v[188:191], v[176:179], v[32:47]
    v_mfma_f32_32x32x16_bf16 v[48:63], v[184:187], v[180:183], v[48:63]
    v_mfma_f32_32x32x16_bf16 v[64:79], v[188:191], v[180:183], v[64:79]
    buffer_load_dwordx4 v[176:179], v4, s[36:39], s7 offen offset:2048
    buffer_load_dwordx4 v[180:183], v4, s[36:39], s9 offen offset:2048
    buffer_load_dwordx4 v[184:187], v4, s[36:39], s10 offen offset:2048
    buffer_load_dwordx4 v[188:191], v4, s[36:39], s11 offen offset:2048
    s_waitcnt vmcnt(36)
    v_mfma_f32_32x32x16_bf16 v[16:31], v[200:203], v[192:195], v[16:31]
    v_mfma_f32_32x32x16_bf16 v[32:47], v[204:207], v[192:195], v[32:47]
    v_mfma_f32_32x32x16_bf16 v[48:63], v[200:203], v[196:199], v[48:63]
    v_mfma_f32_32x32x16_bf16 v[64:79], v[204:207], v[196:199], v[64:79]
    buffer_load_dwordx4 v[192:195], v4, s[36:39], s7 offen offset:3072
    buffer_load_dwordx4 v[196:199], v4, s[36:39], s9 offen offset:3072
    buffer_load_dwordx4 v[200:203], v4, s[36:39], s10 offen offset:3072
    buffer_load_dwordx4 v[204:207], v4, s[36:39], s11 offen offset:3072
    s_add_u32 s7, s7, 4096
    s_add_u32 s9, s9, 4096
    s_add_u32 s10, s10, 4096
    s_add_u32 s11, s11, 4096
    s_waitcnt vmcnt(36)
    v_mfma_f32_32x32x16_bf16 v[16:31], v[216:219], v[208:211], v[16:31]
    v_mfma_f32_32x32x16_bf16 v[32:47], v[220:223], v[208:211], v[32:47]
    v_mfma_f32_32x32x16_bf16 v[48:63], v[216:219], v[212:215], v[48:63]
    v_mfma_f32_32x32x16_bf16 v[64:79], v[220:223], v[212:215], v[64:79]
    s_waitcnt vmcnt(32)
    v_mfma_f32_32x32x16_bf16 v[16:31], v[232:235], v[224:227], v[16:31]
    v_mfma_f32_32x32x16_bf16 v[32:47], v[236:239], v[224:227], v[32:47]
    v_mfma_f32_32x32x16_bf16 v[48:63], v[232:235], v[228:231], v[48:63]
    v_mfma_f32_32x32x16_bf16 v[64:79], v[236:239], v[228:231], v[64:79]
    s_waitcnt vmcnt(28)
    v_mfma_f32_32x32x16_bf16 v[16:31], v[88:91], v[80:83], v[16:31]
    v_mfma_f32_32x32x16_bf16 v[32:47], v[92:95], v[80:83], v[32:47]
    v_mfma_f32_32x32x16_bf16 v[48:63], v[88:91], v[84:87], v[48:63]
    v_mfma_f32_32x32x16_bf16 v[64:79], v[92:95], v[84:87], v[64:79]
    s_waitcnt vmcnt(24)
    v_mfma_f32_32x32x16_bf16 v[16:31], v[104:107], v[96:99], v[16:31]
    v_mfma_f32_32x32x16_bf16 v[32:47], v[108:111], v[96:99], v[32:47]
    v_mfma_f32_32x32x16_bf16 v[48:63], v[104:107], v[100:103], v[48:63]
    v_mfma_f32_32x32x16_bf16 v[64:79], v[108:111], v[100:103], v[64:79]
    s_waitcnt vmcnt(20)
    v_mfma_f32_32x32x16_bf16 v[16:31], v[120:123], v[112:115], v[16:31]
    v_mfma_f32_32x32x16_bf16 v[32:47], v[124:127], v[112:115], v[32:47]
    v_mfma_f32_32x32x16_bf16 v[48:63], v[120:123], v[116:119], v[48:63]
    v_mfma_f32_32x32x16_bf16 v[64:79], v[124:127], v[116:119], v[64:79]
    s_waitcnt vmcnt(16)
    v_mfma_f32_32x32x16_bf16 v[16:31], v[136:139], v[128:131], v[16:31]
    v_mfma_f32_32x32x16_bf16 v[32:47], v[140:143], v[128:131], v[32:47]
    v_mfma_f32_32x32x16_bf16 v[48:63], v[136:139], v[132:135], v[48:63]
    v_mfma_f32_32x32x16_bf16 v[64:79], v[140:143], v[132:135], v[64:79]
    s_waitcnt vmcnt(12)
    v_mfma_f32_32x32x16_bf16 v[16:31], v[152:155], v[144:147], v[16:31]
    v_mfma_f32_32x32x16_bf16 v[32:47], v[156:159], v[144:147], v[32:47]
    v_mfma_f32_32x32x16_bf16 v[48:63], v[152:155], v[148:151], v[48:63]
    v_mfma_f32_32x32x16_bf16 v[64:79], v[156:159], v[148:151], v[64:79]
    s_waitcnt vmcnt(8)
    v_mfma_f32_32x32x16_bf16 v[16:31], v[168:171], v[160:163], v[16:31]
    v_mfma_f32_32x32x16_bf16 v[32:47], v[172:175], v[160:163], v[32:47]
    v_mfma_f32_32x32x16_bf16 v[48:63], v[168:171], v[164:167], v[48:63]
    v_mfma_f32_32x32x16_bf16 v[64:79], v[172:175], v[164:167], v[64:79]
    s_waitcnt vmcnt(4)
    v_mfma_f32_32x32x16_bf16 v[16:31], v[184:187], v[176:179], v[16:31]
    v_mfma_f32_32x32x16_bf16 v[32:47], v[188:191], v[176:179], v[32:47]
    v_mfma_f32_32x32x16_bf16 v[48:63], v[184:187], v[180:183], v[48:63]
    v_mfma_f32_32x32x16_bf16 v[64:79], v[188:191], v[180:183], v[64:79]
    s_waitcnt vmcnt(0)
    v_mfma_f32_32x32x16_bf16 v[16:31], v[200:203], v[192:195], v[16:31]
    v_mfma_f32_32x32x16_bf16 v[32:47], v[204:207], v[192:195], v[32:47]
    v_mfma_f32_32x32x16_bf16 v[48:63], v[200:203], v[196:199], v[48:63]
    v_mfma_f32_32x32x16_bf16 v[64:79], v[204:207], v[196:199], v[64:79]
    s_nop 11
    s_lshl_b32 s8, s6, 14
    v_add_u32 v5, s8, v4
    ds_write_b128 v5, v[16:19] offset:0
    ds_write_b128 v5, v[20:23] offset:1024
    ds_write_b128 v5, v[24:27] offset:2048
    ds_write_b128 v5, v[28:31] offset:3072
    ds_write_b128 v5, v[32:35] offset:4096
    ds_write_b128 v5, v[36:39] offset:5120
    ds_write_b128 v5, v[40:43] offset:6144
    ds_write_b128 v5, v[44:47] offset:7168
    ds_write_b128 v5, v[48:51] offset:8192
    ds_write_b128 v5, v[52:55] offset:9216
    ds_write_b128 v5, v[56:59] offset:10240
    ds_write_b128 v5, v[60:63] offset:11264
    ds_write_b128 v5, v[64:67] offset:12288
    ds_write_b128 v5, v[68:71] offset:13312
    ds_write_b128 v5, v[72:75] offset:14336
    ds_write_b128 v5, v[76:79] offset:15360
    v_lshlrev_b32 v6, 4, v3
    v_lshlrev_b32 v9, 2, v2
    s_lshl_b32 s10, s12, 7
    s_add_u32 s10, s10, 0x1a02300
    buffer_load_dword v224, v9, s[36:39], s10 offen
    s_add_u32 s10, s10, 10752
    buffer_load_dword v225, v9, s[36:39], s10 offen
    s_add_u32 s10, s10, 10752
    buffer_load_dword v226, v9, s[36:39], s10 offen
    s_add_u32 s10, s10, 10752
    buffer_load_dword v227, v9, s[36:39], s10 offen
    s_add_u32 s10, s10, 10752
    buffer_load_dword v228, v9, s[36:39], s10 offen
    s_add_u32 s10, s10, 10752
    buffer_load_dword v229, v9, s[36:39], s10 offen
    s_add_u32 s10, s10, 10752
    buffer_load_dword v230, v9, s[36:39], s10 offen
    s_add_u32 s10, s10, 10752
    buffer_load_dword v231, v9, s[36:39], s10 offen
    s_waitcnt lgkmcnt(0)
    s_barrier
    s_lshl_b32 s8, s6, 12
    v_add_u32 v5, s8, v4
    ds_read_b128 v[80:83], v5 offset:0
    ds_read_b128 v[84:87], v5 offset:1024
    ds_read_b128 v[88:91], v5 offset:2048
    ds_read_b128 v[92:95], v5 offset:3072
    ds_read_b128 v[96:99], v5 offset:16384
    ds_read_b128 v[100:103], v5 offset:17408
    ds_read_b128 v[104:107], v5 offset:18432
    ds_read_b128 v[108:111], v5 offset:19456
    ds_read_b128 v[112:115], v5 offset:32768
    ds_read_b128 v[116:119], v5 offset:33792
    ds_read_b128 v[120:123], v5 offset:34816
    ds_read_b128 v[124:127], v5 offset:35840
    ds_read_b128 v[128:131], v5 offset:49152
    ds_read_b128 v[132:135], v5 offset:50176
    ds_read_b128 v[136:139], v5 offset:51200
    ds_read_b128 v[140:143], v5 offset:52224
    s_waitcnt lgkmcnt(0) vmcnt(0)
    v_add_f32 v224, v224, v228
    v_add_f32 v225, v225, v229
    v_add_f32 v226, v226, v230
    v_add_f32 v227, v227, v231
    v_add_f32 v224, v224, v226
    v_add_f32 v225, v225, v227
    v_add_f32 v224, v224, v225
    v_cvt_pk_bf16_f32 v224, v224, v224
    v_lshlrev_b32 v224, 16, v224
    v_mul_f32 v224, 0xbf317218, v224
    s_lshl_b32 s10, s6, 7
    s_add_u32 s10, s10, 65536
    v_add_u32 v9, s10, v9
    v_add_u32 v6, s10, v6
    ds_write_b32 v9, v224
    s_waitcnt lgkmcnt(0)
    ds_read_b128 v[224:227], v6 offset:0
    ds_read_b128 v[228:231], v6 offset:32
    ds_read_b128 v[232:235], v6 offset:64
    ds_read_b128 v[236:239], v6 offset:96
    s_waitcnt lgkmcnt(0)
    v_add_f32 v80, v80, v96
    v_add_f32 v81, v81, v97
    v_add_f32 v82, v82, v98
    v_add_f32 v83, v83, v99
    v_add_f32 v84, v84, v100
    v_add_f32 v85, v85, v101
    v_add_f32 v86, v86, v102
    v_add_f32 v87, v87, v103
    v_add_f32 v88, v88, v104
    v_add_f32 v89, v89, v105
    v_add_f32 v90, v90, v106
    v_add_f32 v91, v91, v107
    v_add_f32 v92, v92, v108
    v_add_f32 v93, v93, v109
    v_add_f32 v94, v94, v110
    v_add_f32 v95, v95, v111
    v_add_f32 v80, v80, v112
    v_add_f32 v81, v81, v113
    v_add_f32 v82, v82, v114
    v_add_f32 v83, v83, v115
    v_add_f32 v84, v84, v116
    v_add_f32 v85, v85, v117
    v_add_f32 v86, v86, v118
    v_add_f32 v87, v87, v119
    v_add_f32 v88, v88, v120
    v_add_f32 v89, v89, v121
    v_add_f32 v90, v90, v122
    v_add_f32 v91, v91, v123
    v_add_f32 v92, v92, v124
    v_add_f32 v93, v93, v125
    v_add_f32 v94, v94, v126
    v_add_f32 v95, v95, v127
    v_add_f32 v80, v80, v128
    v_add_f32 v81, v81, v129
    v_add_f32 v82, v82, v130
    v_add_f32 v83, v83, v131
    v_add_f32 v84, v84, v132
    v_add_f32 v85, v85, v133
    v_add_f32 v86, v86, v134
    v_add_f32 v87, v87, v135
    v_add_f32 v88, v88, v136
    v_add_f32 v89, v89, v137
    v_add_f32 v90, v90, v138
    v_add_f32 v91, v91, v139
    v_add_f32 v92, v92, v140
    v_add_f32 v93, v93, v141
    v_add_f32 v94, v94, v142
    v_add_f32 v95, v95, v143
    v_lshlrev_b32 v200, 16, v240
    v_fma_f32 v80, v224, v80, v200
    v_and_b32 v200, 0xffff0000, v240
    v_fma_f32 v81, v225, v81, v200
    v_lshlrev_b32 v200, 16, v241
    v_fma_f32 v82, v226, v82, v200
    v_and_b32 v200, 0xffff0000, v241
    v_fma_f32 v83, v227, v83, v200
    v_lshlrev_b32 v200, 16, v242
    v_fma_f32 v84, v228, v84, v200
    v_and_b32 v200, 0xffff0000, v242
    v_fma_f32 v85, v229, v85, v200
    v_lshlrev_b32 v200, 16, v243
    v_fma_f32 v86, v230, v86, v200
    v_and_b32 v200, 0xffff0000, v243
    v_fma_f32 v87, v231, v87, v200
    v_lshlrev_b32 v200, 16, v244
    v_fma_f32 v88, v232, v88, v200
    v_and_b32 v200, 0xffff0000, v244
    v_fma_f32 v89, v233, v89, v200
    v_lshlrev_b32 v200, 16, v245
    v_fma_f32 v90, v234, v90, v200
    v_and_b32 v200, 0xffff0000, v245
    v_fma_f32 v91, v235, v91, v200
    v_lshlrev_b32 v200, 16, v246
    v_fma_f32 v92, v236, v92, v200
    v_and_b32 v200, 0xffff0000, v246
    v_fma_f32 v93, v237, v93, v200
    v_lshlrev_b32 v200, 16, v247
    v_fma_f32 v94, v238, v94, v200
    v_and_b32 v200, 0xffff0000, v247
    v_fma_f32 v95, v239, v95, v200
    v_cvt_pk_bf16_f32 v80, v80, v81
    v_cvt_pk_bf16_f32 v81, v82, v83
    v_cvt_pk_bf16_f32 v82, v84, v85
    v_cvt_pk_bf16_f32 v83, v86, v87
    v_cvt_pk_bf16_f32 v84, v88, v89
    v_cvt_pk_bf16_f32 v85, v90, v91
    v_cvt_pk_bf16_f32 v86, v92, v93
    v_cvt_pk_bf16_f32 v87, v94, v95
    v_mul_u32_u24 v7, 896, v2
    v_lshl_add_u32 v7, v3, 3, v7
    s_mul_i32 s9, s15, 28672
    s_lshl_b32 s10, s12, 6
    s_add_u32 s9, s9, s10
    buffer_store_dwordx2 v[80:81], v7, s[40:43], s9 offen offset:0
    buffer_store_dwordx2 v[82:83], v7, s[40:43], s9 offen offset:16
    buffer_store_dwordx2 v[84:85], v7, s[40:43], s9 offen offset:32
    buffer_store_dwordx2 v[86:87], v7, s[40:43], s9 offen offset:48
K6_END:
    s_endpgm
.section .rodata,"a"
.p2align 6
.amdhsa_kernel prep_kernel
  .amdhsa_next_free_vgpr 256
  .amdhsa_next_free_sgpr 102
  .amdhsa_accum_offset 256
  .amdhsa_group_segment_fixed_size 0
  .amdhsa_kernarg_size 88
  .amdhsa_user_sgpr_count 2
  .amdhsa_user_sgpr_kernarg_segment_ptr 1
  .amdhsa_system_sgpr_workgroup_id_x 1
.end_amdhsa_kernel
.p2align 6
.amdhsa_kernel qkv_kernel
  .amdhsa_next_free_vgpr 256
  .amdhsa_next_free_sgpr 102
  .amdhsa_accum_offset 256
  .amdhsa_group_segment_fixed_size 0
  .amdhsa_kernarg_size 88
  .amdhsa_user_sgpr_count 2
  .amdhsa_user_sgpr_kernarg_segment_ptr 1
  .amdhsa_system_sgpr_workgroup_id_x 1
.end_amdhsa_kernel
.p2align 6
.amdhsa_kernel attn_kernel
  .amdhsa_next_free_vgpr 256
  .amdhsa_next_free_sgpr 102
  .amdhsa_accum_offset 256
  .amdhsa_group_segment_fixed_size 0
  .amdhsa_kernarg_size 88
  .amdhsa_user_sgpr_count 2
  .amdhsa_user_sgpr_kernarg_segment_ptr 1
  .amdhsa_system_sgpr_workgroup_id_x 1
.end_amdhsa_kernel
.p2align 6
.amdhsa_kernel ffn1_kernel
  .amdhsa_next_free_vgpr 256
  .amdhsa_next_free_sgpr 102
  .amdhsa_accum_offset 256
  .amdhsa_group_segment_fixed_size 0
  .amdhsa_kernarg_size 88
  .amdhsa_user_sgpr_count 2
  .amdhsa_user_sgpr_kernarg_segment_ptr 1
  .amdhsa_system_sgpr_workgroup_id_x 1
.end_amdhsa_kernel
.p2align 6
.amdhsa_kernel ffn2_kernel
  .amdhsa_next_free_vgpr 256
  .amdhsa_next_free_sgpr 102
  .amdhsa_accum_offset 256
  .amdhsa_group_segment_fixed_size 0
  .amdhsa_kernarg_size 88
  .amdhsa_user_sgpr_count 2
  .amdhsa_user_sgpr_kernarg_segment_ptr 1
  .amdhsa_system_sgpr_workgroup_id_x 1
.end_amdhsa_kernel
```
